```python
import torch

def _softmax(x, axis=-1):
    return torch.softmax(x, dim=axis)
def _gelu(x):
    return torch.nn.functional.gelu(x, approximate="tanh")
def _silu(x):
    return torch.nn.functional.silu(x)
def _sigmoid(x):
    return torch.sigmoid(x)
def _layernorm(x, axis=-1, eps=1e-5):
    m = x.mean(dim=axis, keepdim=True)
    v = x.var(dim=axis, keepdim=True, unbiased=False)
    return (x - m) / torch.sqrt(v + eps)
def _scatter_add(tgt, idx, src, axis=0):
    return tgt.clone().index_add_(axis, idx, src)
def _segment_sum(src, seg, n):
    out = torch.zeros((n,) + src.shape[1:], dtype=src.dtype)
    return out.index_add_(0, seg, src)
def _pad(x, pw):
    flat = tuple(v for pair in reversed(pw) for v in pair)
    return torch.nn.functional.pad(x, flat)

kernel_name = 'standalone__mpnn_edge_mlp__graph'

def setup_inputs():

    _w = (lambda a: (lambda t: t.to(torch.bfloat16) if t.is_floating_point() else t)(torch.as_tensor(a)))
    N, deg, D, De = 25000, 32, 64, max(0, 1)
    E = N * deg
    return {
        "x": _w((lambda *s: torch.randn(*s, dtype=torch.bfloat16) * 0.05)(N, D)),
        "e_attr": _w((lambda *s: torch.randn(*s, dtype=torch.bfloat16) * 0.4)(E, De)),
        "src": _w((lambda lo, hi, *s: torch.randint(lo, hi, s))(0, N, E).to(torch.int64)),
        "dst": _w((lambda lo, hi, *s: torch.randint(lo, hi, s))(0, N, E).to(torch.int64)),
        "w_msg": _w((lambda *s: torch.randn(*s, dtype=torch.bfloat16) * 0.4)(2 * D + De, D)),
        "w_upd": _w((lambda *s: torch.randn(*s, dtype=torch.bfloat16) * 0.05)(2 * D, D)),
    }

def reference(x, e_attr, src, dst, w_msg, w_upd):
    N, D = x.shape
    m_in = torch.concatenate([x[src], x[dst], e_attr], axis=-1)
    msg = _silu(m_in @ w_msg)
    agg = _segment_sum(msg, dst, N)
    return _silu(torch.concatenate([x, agg], axis=-1) @ w_upd)
```

```asm
; @launch grid=(256,1,1) block=(512,1,1) lds=163488
.amdgcn_target "amdgcn-amd-amdhsa--gfx950"
.text
.globl standalone__mpnn_edge_mlp__graph_kernel
.p2align 12
.type standalone__mpnn_edge_mlp__graph_kernel,@function
standalone__mpnn_edge_mlp__graph_kernel:
    s_cmp_ge_u32 s2, 256
    s_cbranch_scc1 L_end
    s_load_dwordx16 s[64:79], s[0:1], 0
    s_load_dwordx2 s[80:81], s[0:1], 64
    v_lshrrev_b32 v2, 6, v0
    s_mul_i32 s40, s2, 3125
    v_readfirstlane_b32 s17, v2
    s_lshr_b32 s41, s40, 3
    s_add_u32 s40, s40, 3125
    s_lshr_b32 s40, s40, 3
    s_sub_u32 s40, s40, s41
    s_cmp_eq_u32 s17, 7
    s_cbranch_scc1 L_touch
L_back7:
    v_lshlrev_b32 v207, 4, v0
    s_lshl_b32 s41, s41, 5
    v_add_u32 v202, s41, v207
    s_lshl_b32 s3, s40, 4
    v_add_u32 v203, s3, v202
    v_cmp_gt_u32_e64 s[56:57], s40, v0
    v_mov_b32 v128, 0
    v_mov_b32 v129, 0
    v_mov_b32 v130, 0
    v_mov_b32 v131, 0
    v_lshrrev_b32 v164, 1, v202
    v_lshrrev_b32 v165, 1, v203
    v_and_b32 v1, 63, v0
    v_lshlrev_b32 v30, 4, v1
    s_cmp_eq_u32 s17, 7
    s_waitcnt lgkmcnt(0)
    s_cbranch_scc1 L_clr
    s_mov_b64 exec, s[56:57]
    global_load_dwordx4 v[144:147], v202, s[70:71]
    global_load_dwordx4 v[148:151], v203, s[70:71]
    s_mov_b64 exec, -1
    ds_write_b128 v207, v[128:131] offset:32256
    ds_write_b128 v207, v[128:131] offset:39424
    ds_write_b128 v207, v[128:131] offset:46592
    s_sleep 18
    s_mov_b64 exec, s[56:57]
    global_load_dwordx4 v[152:155], v202, s[68:69]
    global_load_dwordx4 v[156:159], v203, s[68:69]
    global_load_dwordx2 v[160:161], v164, s[66:67]
    global_load_dwordx2 v[162:163], v165, s[66:67]
    s_mov_b64 exec, -1
    s_branch L_setup
L_touch:
    s_bitcmp1_b32 s2, 3
    s_cbranch_scc1 L_tr4_4
    s_bitcmp1_b32 s2, 4
    s_cbranch_scc1 L_tr2_2
    s_bitcmp1_b32 s2, 5
    s_cbranch_scc1 L_pad1
    s_branch L_pad0
L_tr2_2:
    s_bitcmp1_b32 s2, 5
    s_cbranch_scc1 L_pad3
    s_branch L_pad2
L_tr4_4:
    s_bitcmp1_b32 s2, 4
    s_cbranch_scc1 L_tr6_2
    s_bitcmp1_b32 s2, 5
    s_cbranch_scc1 L_pad5
    s_branch L_pad4
L_tr6_2:
    s_bitcmp1_b32 s2, 5
    s_cbranch_scc1 L_pad7
    s_branch L_pad6
L_clr:
    s_cmp_ge_u32 s2, 32
    s_cbranch_scc1 L_b0
    s_sleep 8
    s_lshl_b32 s3, s2, 13
    s_add_u32 s3, s3, 5246976
    v_add_u32 v2, s3, v30
    s_lshl_b32 s3, s2, 7
    s_add_u32 s3, s3, 5505024
    v_add_u32 v3, s3, v30
    global_store_dwordx4 v2, v[128:131], s[80:81] offset:-4096 sc1
    global_store_dwordx4 v2, v[128:131], s[80:81] offset:-3072 sc1
    global_store_dwordx4 v2, v[128:131], s[80:81] offset:-2048 sc1
    global_store_dwordx4 v2, v[128:131], s[80:81] offset:-1024 sc1
    global_store_dwordx4 v2, v[128:131], s[80:81] offset:0 sc1
    global_store_dwordx4 v2, v[128:131], s[80:81] offset:1024 sc1
    global_store_dwordx4 v2, v[128:131], s[80:81] offset:2048 sc1
    global_store_dwordx4 v2, v[128:131], s[80:81] offset:3072 sc1
    s_mov_b64 exec, 0xff
    global_store_dwordx4 v3, v[128:131], s[80:81] sc1
    s_mov_b64 exec, -1
L_b0:
    s_barrier
L_setup:
    s_and_b32 s16, s2, 7
    s_lshl_b32 s16, s16, 5
    s_lshr_b32 s3, s2, 3
    s_add_u32 s16, s16, s3
    s_lshl_b32 s43, s17, 11
    v_and_b32 v2, 7, v1
    v_lshrrev_b32 v3, 4, v1
    v_xor_b32 v3, v2, v3
    v_lshlrev_b32 v23, 4, v3
    v_xor_b32 v21, 64, v23
    v_and_b32 v32, 31, v1
    v_lshrrev_b32 v33, 5, v1
    v_and_b32 v2, 19, v32
    v_bfe_u32 v3, v32, 2, 1
    v_lshl_or_b32 v2, v3, 3, v2
    v_bfe_u32 v3, v32, 3, 1
    v_lshl_or_b32 v34, v3, 2, v2
    v_lshlrev_b32 v37, 1, v34
    s_mov_b32 s8, s80
    s_mov_b32 s9, s81
    s_mov_b32 s10, 5767168
    s_mov_b32 s11, 0x00020000
    s_add_u32 s4, s80, 5764096
    s_addc_u32 s5, s81, 0
    s_and_b32 s5, s5, 0xffff
    s_or_b32 s5, s5, 0x800000
    s_mov_b32 s6, 25088
    s_mov_b32 s7, 0x00020000
    s_mov_b32 s12, s76
    s_mov_b32 s13, s77
    s_mov_b32 s14, 3200000
    s_mov_b32 s15, 0x00020000
    s_mov_b32 s58, 0xbfb8aa3b
    s_mov_b32 s59, 0xbfb8aa3b
    s_and_b32 s48, s17, 3
    s_lshr_b32 s49, s17, 2
    v_and_b32 v2, 15, v1
    v_lshrrev_b32 v3, 4, v1
    v_lshrrev_b32 v12, 1, v2
    v_xor_b32 v12, v12, v3
    v_lshlrev_b32 v12, 4, v12
    v_lshl_add_u32 v12, v2, 7, v12
    s_add_u32 s3, s43, 53760
    v_add_u32 v58, s3, v12
    v_xor_b32 v59, 64, v58
    s_lshl_b32 s3, s48, 12
    s_add_u32 s3, s3, 53760
    v_add_u32 v12, s3, v12
    v_xor_b32 v27, 64, v12
    s_lshl_b32 s46, s49, 2
    v_or_b32 v28, s46, v3
    v_xor_b32 v28, v28, v2
    v_and_b32 v28, 7, v28
    v_lshlrev_b32 v28, 4, v28
    v_lshl_add_u32 v28, v2, 7, v28
    s_add_u32 s45, s43, 34304
    v_add_u32 v28, s45, v28
    v_xor_b32 v57, 64, v28
    s_lshl_b32 s3, s48, 5
    v_add_u32 v2, s3, v2
    v_cmp_gt_u32 vcc, 98, v2
    s_lshl_b32 s3, s49, 7
    s_add_u32 s3, s3, 110080
    v_lshl_add_u32 v26, v3, 5, s3
    s_mov_b64 s[60:61], vcc
    v_cmp_gt_u32 vcc, 82, v2
    s_mov_b32 s3, 272
    v_mad_u32_u24 v26, v2, s3, v26
    s_mov_b64 s[62:63], vcc
    v_bfe_u32 v2, v1, 2, 2
    v_lshl_add_u32 v3, v3, 3, v2
    v_lshrrev_b32 v2, 1, v2
    v_xor_b32 v13, s49, v2
    v_lshlrev_b32 v13, 6, v13
    v_lshl_add_u32 v13, v3, 7, v13
    v_and_b32 v3, 3, v1
    v_lshl_add_u32 v13, v3, 4, v13
    v_add_u32 v13, 77312, v13
    v_xor_b32 v56, 64, v13
    v_lshrrev_b32 v2, 3, v1
    s_lshl_b32 s3, s17, 4
    v_add_u32 v3, s3, v2
    s_mul_i32 s3, s16, 98
    v_cmp_gt_u32 vcc, 98, v3
    v_add_u32 v14, s3, v3
    s_cmp_lt_u32 s17, 6
    s_cselect_b32 s3, 8, 0x10000
    v_add_u32 v24, s3, v14
    v_cndmask_b32 v14, -1, v14, vcc
    v_and_b32 v3, 0x70, v207
    v_add_u32 v15, 3072, v3
    v_mov_b32 v25, v15
    v_lshlrev_b32 v2, 4, v2
    v_xor_b32 v29, v2, v30
    v_add_u32 v29, s45, v29
    v_mov_b32 v208, 0x7f00
    v_mov_b32 v209, 0x7f00
    v_mov_b32 v210, 0x7f00
    v_mov_b32 v211, 0x7f00
    v_lshlrev_b32 v212, 4, v0
    ds_write_b128 v212, v[208:211] offset:6144
    ds_write_b128 v212, v[208:211] offset:14336
    ds_write_b128 v212, v[208:211] offset:22528
    v_cmp_gt_u32 vcc, 83, v0
    v_lshlrev_b32 v213, 2, v0
    s_mov_b32 s40, 260
    v_mov_b32 v214, 5884
    s_mov_b64 exec, vcc
    ds_write_b128 v212, v[208:211] offset:30720
    s_mov_b64 exec, -1
    v_mad_u32_u24 v214, v0, s40, v214
    s_cmp_lt_u32 s16, 168
    s_addc_u32 s40, 97, 0
    v_cmp_lt_u32 vcc, s40, v0
    v_subrev_u32 v215, 4, v214
    v_mov_b32 v212, 136
    v_cndmask_b32 v214, v214, v215, vcc
    v_cmp_gt_u32 vcc, v212, v0
    v_mov_b32 v212, 220
    v_mov_b32 v215, 0
    v_cndmask_b32 v214, v215, v214, vcc
    v_cmp_gt_u32 vcc, v212, v0
    s_mov_b64 exec, vcc
    ds_write_b32 v213, v214
    s_mov_b64 exec, -1
    s_mov_b32 s30, 0
    s_sub_u32 s3, 11, s17
    s_cmp_lt_u32 s17, 4
    s_cselect_b32 s18, s17, s3
    s_mul_i32 s19, s18, 8704
    s_add_u32 s19, s19, 32256
    s_add_u32 s37, s19, 4096
    s_mov_b32 s22, 1.0
    s_mov_b32 s23, 1.0
    s_mov_b32 s39, 20000
    v_add_u32 v17, 3072, v23
    v_add_u32 v19, 2048, v21
    v_add_u32 v21, 1024, v23
    v_xor_b32 v23, 64, v23
    v_bfe_u32 v2, v32, 1, 3
    v_xor_b32 v2, v2, v33
    v_lshlrev_b32 v2, 4, v2
    v_lshl_add_u32 v3, v32, 7, s19
    v_xor_b32 v4, 0, v2
    v_add_u32 v4, v3, v4
    v_xor_b32 v5, 32, v2
    v_add_u32 v5, v3, v5
    v_xor_b32 v6, 64, v2
    v_add_u32 v6, v3, v6
    v_xor_b32 v7, 96, v2
    v_add_u32 v7, v3, v7
    v_lshrrev_b32 v2, 4, v32
    v_xor_b32 v2, v2, v33
    v_bfe_u32 v3, v34, 2, 2
    v_lshl_or_b32 v2, v2, 2, v3
    v_and_b32 v3, 3, v32
    v_mov_b32 v36, 0x5555
    v_mul_u32_u24 v52, v3, v36
    v_mov_b32 v3, 0x3f80
    v_cmp_eq_u32 vcc, 0, v2
    v_cmp_eq_u32_e64 s[48:49], 1, v2
    s_nop 0
    v_cndmask_b32 v48, 0, v3, vcc
    v_cndmask_b32_e64 v49, 0, v3, s[48:49]
    v_cmp_eq_u32 vcc, 2, v2
    v_cmp_eq_u32_e64 s[48:49], 3, v2
    s_nop 0
    v_cndmask_b32 v50, 0, v3, vcc
    v_cndmask_b32_e64 v51, 0, v3, s[48:49]
    v_bfe_u32 v2, v1, 2, 2
    v_lshl_add_u32 v3, v33, 3, v2
    v_lshlrev_b32 v3, 7, v3
    v_lshrrev_b32 v2, 1, v2
    v_lshl_or_b32 v3, v2, 6, v3
    v_bfe_u32 v2, v1, 4, 1
    v_lshl_or_b32 v3, v2, 5, v3
    v_and_b32 v2, 1, v1
    v_lshl_or_b32 v3, v2, 4, v3
    v_bfe_u32 v2, v1, 1, 1
    v_lshl_or_b32 v3, v2, 3, v3
    v_xor_b32 v2, 64, v3
    v_add_u32 v72, 101888, v3
    v_add_u32 v73, 101888, v2
    s_lshl_b32 s3, s18, 7
    s_add_u32 s3, s3, s19
    v_lshl_add_u32 v35, v32, 2, s3
    v_lshrrev_b32 v2, 2, v0
    v_min_u32 v2, 98, v2
    v_mul_u32_u24 v2, 260, v2
    s_branch L_over0
L_pad0:
    s_branch L_back7
L_over0:
    v_and_b32 v3, 3, v0
    v_min_u32 v3, 2, v3
    v_lshl_add_u32 v54, v3, 2, v2
    v_lshrrev_b32 v2, 3, v1
    s_lshl_b32 s3, s17, 12
    s_add_u32 s3, s3, s16
    v_lshl_add_u32 v2, v2, 8, s3
    v_add_u32 v3, 2048, v2
    v_min_u32 v2, 24999, v2
    v_min_u32 v3, 24999, v3
    v_lshl_add_u32 v204, v2, 7, v23
    v_lshl_add_u32 v205, v3, 7, v23
    v_xor_b32 v204, 64, v204
    v_subrev_u32 v205, 1024, v205
    v_and_b32 v2, 16, v1
    v_lshlrev_b32 v2, 2, v2
    v_xor_b32 v206, v2, v207
    s_lshr_b32 s42, s43, 1
    s_add_u32 s42, s42, 77312
    v_lshrrev_b32 v2, 3, v0
    v_lshlrev_b32 v8, 9, v2
    v_and_b32 v2, 7, v0
    v_mov_b32 v3, 0xff800010
    v_mul_lo_u32 v2, v2, v3
    v_subrev_u32 v9, 0x80800000, v2
    s_lshl_b32 s3, s2, 7
    s_add_u32 s3, s3, 5242880
    v_lshrrev_b32 v2, 3, v1
    v_lshl_add_u32 v10, v2, 15, s3
    v_and_b32 v2, 127, v30
    v_add_u32 v10, v2, v10
    s_lshr_b32 s47, s16, 5
    s_lshl_b32 s47, s47, 13
    s_and_b32 s3, s16, 31
    s_add_u32 s47, s47, s3
    s_lshl_b32 s47, s47, 2
    s_add_u32 s47, s47, 5242880
    s_mov_b32 s36, 0
    s_mul_i32 s52, s2, 19456
    s_or_b32 s53, s52, 0x80000000
    s_mov_b32 s51, 21846
    s_mov_b32 s50, 98
    v_lshlrev_b32 v113, 2, v1
    s_mov_b32 s82, 4194304
    s_mov_b32 s83, 0
    v_add_u32 v38, 5505024, v30
    s_cmp_eq_u32 s17, 7
    v_mov_b32 v2, 1
    s_waitcnt lgkmcnt(0)
    s_barrier
    s_cbranch_scc1 L_w7f
    s_mov_b64 exec, s[56:57]
    s_waitcnt vmcnt(5)
    v_lshlrev_b32_sdwa v168, 2, v144 dst_sel:DWORD dst_unused:UNUSED_PAD src0_sel:DWORD src1_sel:BYTE_0
    ds_add_rtn_u32 v176, v168, v2 offset:32256
    v_lshlrev_b32_sdwa v169, 2, v145 dst_sel:DWORD dst_unused:UNUSED_PAD src0_sel:DWORD src1_sel:BYTE_0
    ds_add_rtn_u32 v177, v169, v2 offset:32256
    v_lshlrev_b32_sdwa v170, 2, v146 dst_sel:DWORD dst_unused:UNUSED_PAD src0_sel:DWORD src1_sel:BYTE_0
    ds_add_rtn_u32 v178, v170, v2 offset:32256
    v_lshlrev_b32_sdwa v171, 2, v147 dst_sel:DWORD dst_unused:UNUSED_PAD src0_sel:DWORD src1_sel:BYTE_0
    ds_add_rtn_u32 v179, v171, v2 offset:32256
    s_waitcnt vmcnt(4)
    v_lshlrev_b32_sdwa v172, 2, v148 dst_sel:DWORD dst_unused:UNUSED_PAD src0_sel:DWORD src1_sel:BYTE_0
    ds_add_rtn_u32 v180, v172, v2 offset:32256
    v_lshlrev_b32_sdwa v173, 2, v149 dst_sel:DWORD dst_unused:UNUSED_PAD src0_sel:DWORD src1_sel:BYTE_0
    ds_add_rtn_u32 v181, v173, v2 offset:32256
    v_lshlrev_b32_sdwa v174, 2, v150 dst_sel:DWORD dst_unused:UNUSED_PAD src0_sel:DWORD src1_sel:BYTE_0
    ds_add_rtn_u32 v182, v174, v2 offset:32256
    v_lshlrev_b32_sdwa v175, 2, v151 dst_sel:DWORD dst_unused:UNUSED_PAD src0_sel:DWORD src1_sel:BYTE_0
    ds_add_rtn_u32 v183, v175, v2 offset:32256
    v_lshrrev_b32 v144, 8, v144
    v_add_u32 v144, 1, v144
    v_lshrrev_b32 v145, 8, v145
    v_add_u32 v145, 1, v145
    v_lshrrev_b32 v146, 8, v146
    v_add_u32 v146, 1, v146
    v_lshrrev_b32 v147, 8, v147
    v_add_u32 v147, 1, v147
    v_lshrrev_b32 v148, 8, v148
    v_add_u32 v148, 1, v148
    v_lshrrev_b32 v149, 8, v149
    v_add_u32 v149, 1, v149
    v_lshrrev_b32 v150, 8, v150
    v_add_u32 v150, 1, v150
    v_lshrrev_b32 v151, 8, v151
    v_add_u32 v151, 1, v151
    s_waitcnt lgkmcnt(7)
    v_mul_u32_u24 v184, s51, v176
    v_lshrrev_b32 v184, 16, v184
    v_mad_u32_u24 v192, v184, 13, v176
    v_add_lshl_u32 v184, v184, v176, 2
    s_waitcnt lgkmcnt(6)
    v_mul_u32_u24 v185, s51, v177
    v_lshrrev_b32 v185, 16, v185
    v_mad_u32_u24 v193, v185, 13, v177
    v_add_lshl_u32 v185, v185, v177, 2
    s_waitcnt lgkmcnt(5)
    v_mul_u32_u24 v186, s51, v178
    v_lshrrev_b32 v186, 16, v186
    v_mad_u32_u24 v194, v186, 13, v178
    v_add_lshl_u32 v186, v186, v178, 2
    s_waitcnt lgkmcnt(4)
    v_mul_u32_u24 v187, s51, v179
    v_lshrrev_b32 v187, 16, v187
    v_mad_u32_u24 v195, v187, 13, v179
    v_add_lshl_u32 v187, v187, v179, 2
    s_mov_b64 exec, -1
    s_cmp_eq_u32 s17, 6
    s_waitcnt lgkmcnt(0)
    s_barrier
    ds_read_b128 v[208:211], v30 offset:32256
    s_mov_b32 m0, s42
    v_add_u32 v202, 8192, v206
    global_load_lds_dwordx4 v206, s[72:73]
    s_add_u32 m0, s43, 53760
    s_nop 0
    global_load_lds_dwordx4 v204, s[64:65]
    global_load_lds_dwordx4 v205, s[64:65] offset:1024
    s_cmp_eq_u32 s17, 6
    v_mul_u32_u24 v188, s51, v180
    v_lshrrev_b32 v188, 16, v188
    v_mul_u32_u24 v189, s51, v181
    v_lshrrev_b32 v189, 16, v189
    v_mul_u32_u24 v190, s51, v182
    v_lshrrev_b32 v190, 16, v190
    v_mul_u32_u24 v191, s51, v183
    v_lshrrev_b32 v191, 16, v191
    s_waitcnt lgkmcnt(0)
    v_add_u32 v208, 2, v208
    v_mul_u32_u24 v208, s51, v208
    v_lshrrev_b32 v208, 16, v208
    v_add_u32 v209, 2, v209
    v_mul_u32_u24 v209, s51, v209
    v_lshrrev_b32 v209, 16, v209
    v_add_u32 v210, 2, v210
    v_mul_u32_u24 v210, s51, v210
    v_lshrrev_b32 v210, 16, v210
    v_add_u32 v211, 2, v211
    v_mul_u32_u24 v211, s51, v211
    v_lshrrev_b32 v211, 16, v211
    v_add_u32 v212, v208, v209
    v_add_u32 v213, v212, v210
    v_add_u32 v214, v213, v211
    v_mov_b32 v215, v214
    v_mad_u32_u24 v196, v188, 13, v180
    v_mad_u32_u24 v197, v189, 13, v181
    v_add_u32_dpp v215, v215, v215 row_shr:1 row_mask:0xf bank_mask:0xf
    v_mad_u32_u24 v198, v190, 13, v182
    v_mad_u32_u24 v199, v191, 13, v183
    v_add_u32_dpp v215, v215, v215 row_shr:2 row_mask:0xf bank_mask:0xf
    v_add_lshl_u32 v188, v188, v180, 2
    v_add_lshl_u32 v189, v189, v181, 2
    v_add_u32_dpp v215, v215, v215 row_shr:4 row_mask:0xf bank_mask:0xf
    v_add_lshl_u32 v190, v190, v182, 2
    v_add_lshl_u32 v191, v191, v183, 2
    v_add_u32_dpp v215, v215, v215 row_shr:8 row_mask:0xf bank_mask:0xf
    v_min_u32 v76, 255, v208
    v_min_u32 v77, 255, v209
    v_add_u32_dpp v215, v215, v215 row_bcast:15 row_mask:0xa bank_mask:0xf
    v_min_u32 v78, 255, v210
    v_min_u32 v79, 255, v211
    v_add_u32_dpp v215, v215, v215 row_bcast:31 row_mask:0xc bank_mask:0xf
    v_sub_u32 v216, v215, v214
    v_add_lshl_u32 v217, v216, v208, 4
    v_add_lshl_u32 v218, v216, v212, 4
    v_add_lshl_u32 v219, v216, v213, 4
    v_lshlrev_b32 v216, 4, v216
    v_readlane_b32 s54, v215, 63
    ds_write_b128 v30, v[216:219] offset:33280
    s_mov_b64 exec, s[56:57]
    ds_read_b32 v176, v168 offset:33280
    ds_read_b32 v177, v169 offset:33280
    ds_read_b32 v178, v170 offset:33280
    ds_read_b32 v179, v171 offset:33280
    s_branch L_over1
L_pad1:
    s_branch L_back7
L_over1:
    ds_read_b32 v180, v172 offset:33280
    ds_read_b32 v181, v173 offset:33280
    ds_read_b32 v182, v174 offset:33280
    ds_read_b32 v183, v175 offset:33280
    s_waitcnt lgkmcnt(7)
    v_add_u32 v192, v192, v176
    v_add_u32 v184, v184, v176
    ds_write_b8 v192, v144 offset:34316
    s_waitcnt lgkmcnt(7)
    v_add_u32 v193, v193, v177
    v_add_u32 v185, v185, v177
    ds_write_b8 v193, v145 offset:34316
    s_waitcnt lgkmcnt(7)
    v_add_u32 v194, v194, v178
    v_add_u32 v186, v186, v178
    ds_write_b8 v194, v146 offset:34316
    s_waitcnt lgkmcnt(7)
    v_add_u32 v195, v195, v179
    v_add_u32 v187, v187, v179
    ds_write_b8 v195, v147 offset:34316
    s_waitcnt lgkmcnt(7)
    v_add_u32 v196, v196, v180
    v_add_u32 v188, v188, v180
    ds_write_b8 v196, v148 offset:34316
    s_waitcnt lgkmcnt(7)
    v_add_u32 v197, v197, v181
    v_add_u32 v189, v189, v181
    ds_write_b8 v197, v149 offset:34316
    s_waitcnt lgkmcnt(7)
    v_add_u32 v198, v198, v182
    v_add_u32 v190, v190, v182
    ds_write_b8 v198, v150 offset:34316
    s_waitcnt lgkmcnt(7)
    v_add_u32 v199, v199, v183
    v_add_u32 v191, v191, v183
    ds_write_b8 v199, v151 offset:34316
    s_waitcnt vmcnt(6)
    v_mul_u32_u24_sdwa v168, v152, s50 dst_sel:DWORD dst_unused:UNUSED_PAD src0_sel:BYTE_0 src1_sel:DWORD
    v_mul_u32_u24_sdwa v169, v153, s50 dst_sel:DWORD dst_unused:UNUSED_PAD src0_sel:BYTE_0 src1_sel:DWORD
    v_mul_u32_u24_sdwa v170, v154, s50 dst_sel:DWORD dst_unused:UNUSED_PAD src0_sel:BYTE_0 src1_sel:DWORD
    v_mul_u32_u24_sdwa v171, v155, s50 dst_sel:DWORD dst_unused:UNUSED_PAD src0_sel:BYTE_0 src1_sel:DWORD
    s_waitcnt vmcnt(5)
    v_mul_u32_u24_sdwa v172, v156, s50 dst_sel:DWORD dst_unused:UNUSED_PAD src0_sel:BYTE_0 src1_sel:DWORD
    v_mul_u32_u24_sdwa v173, v157, s50 dst_sel:DWORD dst_unused:UNUSED_PAD src0_sel:BYTE_0 src1_sel:DWORD
    v_mul_u32_u24_sdwa v174, v158, s50 dst_sel:DWORD dst_unused:UNUSED_PAD src0_sel:BYTE_0 src1_sel:DWORD
    v_mul_u32_u24_sdwa v175, v159, s50 dst_sel:DWORD dst_unused:UNUSED_PAD src0_sel:BYTE_0 src1_sel:DWORD
    s_waitcnt vmcnt(4)
    v_lshlrev_b32 v128, 16, v160
    v_lshlrev_b32 v129, 16, v161
    v_add_u32_sdwa v128, v168, v152 dst_sel:WORD_0 dst_unused:UNUSED_PRESERVE src0_sel:DWORD src1_sel:BYTE_1
    v_add_u32_sdwa v160, v169, v153 dst_sel:WORD_0 dst_unused:UNUSED_PRESERVE src0_sel:DWORD src1_sel:BYTE_1
    v_add_u32_sdwa v129, v170, v154 dst_sel:WORD_0 dst_unused:UNUSED_PRESERVE src0_sel:DWORD src1_sel:BYTE_1
    v_add_u32_sdwa v161, v171, v155 dst_sel:WORD_0 dst_unused:UNUSED_PRESERVE src0_sel:DWORD src1_sel:BYTE_1
    ds_write_b32 v184, v128 offset:34304
    ds_write_b32 v185, v160 offset:34304
    ds_write_b32 v186, v129 offset:34304
    ds_write_b32 v187, v161 offset:34304
    s_waitcnt vmcnt(3)
    v_lshlrev_b32 v130, 16, v162
    v_lshlrev_b32 v131, 16, v163
    v_add_u32_sdwa v130, v172, v156 dst_sel:WORD_0 dst_unused:UNUSED_PRESERVE src0_sel:DWORD src1_sel:BYTE_1
    v_add_u32_sdwa v162, v173, v157 dst_sel:WORD_0 dst_unused:UNUSED_PRESERVE src0_sel:DWORD src1_sel:BYTE_1
    v_add_u32_sdwa v131, v174, v158 dst_sel:WORD_0 dst_unused:UNUSED_PRESERVE src0_sel:DWORD src1_sel:BYTE_1
    v_add_u32_sdwa v163, v175, v159 dst_sel:WORD_0 dst_unused:UNUSED_PRESERVE src0_sel:DWORD src1_sel:BYTE_1
    ds_write_b32 v188, v130 offset:34304
    ds_write_b32 v189, v162 offset:34304
    ds_write_b32 v190, v131 offset:34304
    ds_write_b32 v191, v163 offset:34304
    s_mov_b64 exec, -1
    s_cbranch_scc0 L_w7i
    v_lshl_add_u32 v76, v76, 23, s53
    v_add_u32 v76, v76, v216
    v_lshl_add_u32 v77, v77, 23, s53
    v_add_u32 v77, v77, v217
    v_lshl_add_u32 v78, v78, 23, s53
    v_add_u32 v78, v78, v218
    v_lshl_add_u32 v79, v79, 23, s53
    v_add_u32 v79, v79, v219
    s_branch L_w7i
L_w7f:
    v_add_u32 v200, 16384, v30
    s_mov_b32 m0, 896
    s_mov_b64 exec, 0xff
    global_load_lds_dwordx4 v200, s[72:73]
    s_mov_b64 exec, -1
    s_mov_b32 s3, 31
    s_mov_b32 s54, 2048
    s_lshl_b32 s44, s2, 3
    v_mov_b32 v200, s44
    v_mov_b32 v2, 1
    v_mov_b32 v3, 1
    s_mov_b32 m0, s42
    v_add_u32 v202, 8192, v206
    global_load_lds_dwordx4 v206, s[72:73]
    s_add_u32 m0, s43, 53760
    s_nop 0
    global_load_lds_dwordx4 v204, s[64:65]
    global_load_lds_dwordx4 v205, s[64:65] offset:1024
    s_cmp_ge_u32 s2, 32
    s_cbranch_scc1 L_nofl
    s_mov_b64 exec, 1
    s_waitcnt vmcnt(4)
    global_store_dwordx2 v200, v[2:3], s[78:79] sc1
    s_mov_b64 exec, -1
L_nofl:
L_lut:
    s_add_u32 s48, s3, 1
    s_lshr_b32 s48, s48, 1
    s_mul_i32 s49, s48, 3
    v_subrev_u32 v80, 1, v1
    v_max_i32 v80, 0, v80
    v_cmp_lt_u32 vcc, s3, v80
    v_cmp_lt_u32_e64 s[50:51], s49, v80
    v_mov_b32 v81, 2
    v_mov_b32 v82, 32768
    v_mov_b32 v83, 21846
    v_cndmask_b32_e64 v81, v81, 3, vcc
    v_cndmask_b32 v82, v82, v83, vcc
    v_mov_b32 v83, 16384
    v_cndmask_b32_e64 v81, v81, 4, s[50:51]
    v_cndmask_b32_e64 v82, v82, v83, s[50:51]
    v_add3_u32 v83, v80, v81, -1
    v_mul_u32_u24 v83, v83, v82
    v_lshrrev_b32 v83, 16, v83
    v_mov_b32 v84, 0
    v_min_u32 v85, v84, v80
    v_sub_u32 v86, v80, v85
    v_min_u32 v86, v86, v83
    v_add3_u32 v85, v85, v81, -1
    v_max_i32 v85, 0, v85
    v_lshl_or_b32 v85, v85, 25, 0
    v_lshl_or_b32 v92, v86, 16, v85
    v_add_u32 v84, v84, v83
    v_min_u32 v85, v84, v80
    v_sub_u32 v86, v80, v85
    v_min_u32 v86, v86, v83
    v_add3_u32 v85, v85, v81, -3
    v_max_i32 v85, 0, v85
    v_lshl_or_b32 v85, v85, 25, 4
    v_lshl_or_b32 v93, v86, 16, v85
    v_add_u32 v84, v84, v83
    v_min_u32 v85, v84, v80
    v_sub_u32 v86, v80, v85
    v_min_u32 v86, v86, v83
    v_add3_u32 v85, v85, v81, -5
    v_max_i32 v85, 0, v85
    v_lshl_or_b32 v85, v85, 25, 8
    v_lshl_or_b32 v94, v86, 16, v85
    v_add_u32 v84, v84, v83
    v_min_u32 v85, v84, v80
    v_sub_u32 v86, v80, v85
    v_min_u32 v86, v86, v83
    v_add3_u32 v85, v85, v81, -7
    v_max_i32 v85, 0, v85
    v_lshl_or_b32 v85, v85, 25, 12
    v_lshl_or_b32 v95, v86, 16, v85
    v_add_u32 v84, v84, v83
    v_lshl_or_b32 v92, v81, 22, v92
    v_sub_u32 v84, s48, v83
    v_min_u32 v84, 5, v84
    v_mul_u32_u24 v98, 10, v84
    v_cmp_le_u32 vcc, 3, v84
    v_add_u32 v85, 2, v98
    v_mov_b32 v88, v81
    v_mov_b32 v89, 0
    v_cndmask_b32 v98, v98, v85, vcc
    v_cmp_ne_u32 vcc, 0, v1
    v_lshlrev_b64 v[96:97], v98, v[88:89]
    v_mov_b32 v99, 0
    v_cndmask_b32 v96, v89, v96, vcc
    v_cndmask_b32 v97, v89, v97, vcc
    v_lshl_add_u32 v85, v1, 5, s54
    ds_write_b128 v85, v[92:95] offset:0
    ds_write_b128 v85, v[96:99] offset:16
    s_add_u32 s54, s54, 2048
    s_add_u32 s3, s3, 1
    s_cmp_eq_u32 s3, 32
    s_cbranch_scc1 L_lut
    s_mov_b32 s54, 0
L_w7i:
    v_add_u32 v2, 1024, v0
    v_cmp_gt_u32 vcc, s54, v2
    s_add_u32 s53, s52, 8192
    s_add_u32 s54, s52, 16384
    s_waitcnt lgkmcnt(0)
    s_barrier
    ds_read_b128 v[144:147], v207 offset:34304
    ds_read_b128 v[148:151], v207 offset:42496
    ds_read_b128 v[152:155], v207 offset:50688
    s_waitcnt lgkmcnt(2)
    buffer_store_dwordx4 v[144:147], v207, s[8:11], s52 offen sc1
    s_waitcnt lgkmcnt(1)
    buffer_store_dwordx4 v[148:151], v207, s[8:11], s53 offen sc1
    s_waitcnt lgkmcnt(0)
    s_mov_b64 exec, vcc
    buffer_store_dwordx4 v[152:155], v207, s[8:11], s54 offen sc1
    s_mov_b64 exec, -1
L_no3:
    s_mov_b32 s50, 0x807fffff
    s_add_u32 m0, s42, 8192
    v_mov_b32 v114, 0
    global_load_lds_dwordx4 v202, s[72:73]
    s_add_u32 m0, s42, 16384
    s_nop 0
    global_load_lds_dwordx4 v206, s[74:75]
    s_add_u32 m0, s42, 24576
    s_nop 0
    global_load_lds_dwordx4 v202, s[74:75]
    s_waitcnt vmcnt(6)
    s_barrier
    ds_read_b128 v[208:211], v58
    ds_read_b128 v[212:215], v59
    ds_read_b64_tr_b16 v[80:81], v13 offset:0
    ds_read_b64_tr_b16 v[82:83], v13 offset:512
    ds_read_b64_tr_b16 v[84:85], v13 offset:4096
    ds_read_b64_tr_b16 v[86:87], v13 offset:4608
    ds_read_b64_tr_b16 v[88:89], v13 offset:8
    ds_read_b64_tr_b16 v[90:91], v13 offset:520
    ds_read_b64_tr_b16 v[92:93], v13 offset:4104
    ds_read_b64_tr_b16 v[94:95], v13 offset:4616
    ds_read_b64_tr_b16 v[96:97], v56 offset:0
    ds_read_b64_tr_b16 v[98:99], v56 offset:512
    ds_read_b64_tr_b16 v[100:101], v56 offset:4096
    ds_read_b64_tr_b16 v[102:103], v56 offset:4608
    s_waitcnt lgkmcnt(4)
    ds_read_b64_tr_b16 v[104:105], v56 offset:8
    ds_read_b64_tr_b16 v[106:107], v56 offset:520
    ds_read_b64_tr_b16 v[108:109], v56 offset:4104
    ds_read_b64_tr_b16 v[110:111], v56 offset:4616
    ds_read_b128 v[224:227], v12 offset:0
    ds_read_b128 v[228:231], v27 offset:0
    ds_read_b128 v[232:235], v12 offset:2048
    ds_read_b128 v[236:239], v27 offset:2048
    s_branch L_page1
L_fagain:
    s_sleep 1
    global_load_dword v112, v113, s[78:79] sc1
    s_sub_u32 s39, s39, 1
    s_waitcnt vmcnt(0)
    s_cbranch_scc0 L_fpoll
    v_mov_b32 v3, 6
    v_mov_b32 v2, 584
    ds_or_b32 v2, v3
    s_waitcnt lgkmcnt(0)
    s_branch L_barC
L_semi_end:
L2_retry:
    s_add_u32 s35, s35, 1
    s_cmp_lg_u32 s35, 1
    s_cbranch_scc1 L2_retry2
L2_retry1:
    ds_read_b128 v[148:151], v212 offset:4112
    ds_read_b128 v[156:159], v213 offset:4112
    ds_read_b128 v[144:147], v212 offset:4096
    ds_read_b128 v[152:155], v213 offset:4096
    s_branch L2_scan
.p2align 12
L_pad2:
    s_branch L_back7
L_page1:
    v_mfma_f32_16x16x32_bf16 v[240:243], v[80:83], v[208:211], 0
    v_mfma_f32_16x16x32_bf16 v[244:247], v[88:91], v[208:211], 0
    v_mfma_f32_16x16x32_bf16 v[240:243], v[84:87], v[212:215], v[240:243]
    v_mfma_f32_16x16x32_bf16 v[244:247], v[92:95], v[212:215], v[244:247]
    s_waitcnt lgkmcnt(4)
    v_mfma_f32_16x16x32_bf16 v[248:251], v[96:99], v[208:211], 0
    v_mfma_f32_16x16x32_bf16 v[252:255], v[104:107], v[208:211], 0
    v_mfma_f32_16x16x32_bf16 v[248:251], v[100:103], v[212:215], v[248:251]
    v_mfma_f32_16x16x32_bf16 v[252:255], v[108:111], v[212:215], v[252:255]
    s_cmp_lg_u32 s17, 6
    s_cbranch_scc1 L_nofld
    global_load_dword v112, v113, s[78:79] sc1
L_nofld:
    v_mov_b32 v41, 0
    v_pk_mul_f32 v[240:241], v[240:241], s[58:59]
    v_pk_mul_f32 v[242:243], v[242:243], s[58:59]
    v_pk_mul_f32 v[244:245], v[244:245], s[58:59]
    v_pk_mul_f32 v[246:247], v[246:247], s[58:59]
    v_cvt_pk_bf16_f32 v240, v240, v241
    v_cvt_pk_bf16_f32 v241, v242, v243
    v_cvt_pk_bf16_f32 v242, v244, v245
    v_cvt_pk_bf16_f32 v243, v246, v247
    ds_write_b128 v28, v[240:243]
    v_pk_mul_f32 v[248:249], v[248:249], s[58:59]
    v_pk_mul_f32 v[250:251], v[250:251], s[58:59]
    v_pk_mul_f32 v[252:253], v[252:253], s[58:59]
    v_pk_mul_f32 v[254:255], v[254:255], s[58:59]
    v_cvt_pk_bf16_f32 v248, v248, v249
    v_cvt_pk_bf16_f32 v249, v250, v251
    v_cvt_pk_bf16_f32 v250, v252, v253
    v_cvt_pk_bf16_f32 v251, v254, v255
    ds_write_b128 v57, v[248:251]
    ds_read_b128 v[216:219], v29 offset:0
    ds_read_b128 v[220:223], v29 offset:1024
    ds_read_u16 v200, v37 offset:896
    ds_read_u16 v201, v37 offset:960
    s_cmp_lg_u32 s17, 6
    s_waitcnt vmcnt(0) lgkmcnt(0)
    s_cbranch_scc1 L_barC
L_fpoll:
    v_cmp_ne_u32 vcc, 1, v112
    s_cbranch_vccnz L_fagain
L_barC:
    s_barrier
    s_cbranch_scc1 L_nopub
    global_store_dwordx4 v10, v[76:79], s[80:81] sc1
L_nopub:
    ds_read_b32 v114, v114 offset:584
    ds_read_b64_tr_b16 v[96:97], v13 offset:8192
    ds_read_b64_tr_b16 v[98:99], v13 offset:8704
    ds_read_b64_tr_b16 v[100:101], v13 offset:12288
    ds_read_b64_tr_b16 v[102:103], v13 offset:12800
    ds_read_b64_tr_b16 v[104:105], v13 offset:8200
    ds_read_b64_tr_b16 v[106:107], v13 offset:8712
    ds_read_b64_tr_b16 v[108:109], v13 offset:12296
    ds_read_b64_tr_b16 v[110:111], v13 offset:12808
    s_waitcnt lgkmcnt(15)
    buffer_store_dwordx4 v[216:219], v[14:15], s[4:7], 0 idxen offen sc1
    s_waitcnt lgkmcnt(14)
    buffer_store_dwordx4 v[220:223], v[24:25], s[4:7], 0 idxen offen sc1
    s_waitcnt lgkmcnt(0)
    v_cmp_lt_u32_e64 s[44:45], 3, v114
    ds_read_b64_tr_b16 v[80:81], v13 offset:16384
    ds_read_b64_tr_b16 v[82:83], v13 offset:16896
    ds_read_b64_tr_b16 v[84:85], v13 offset:20480
    ds_read_b64_tr_b16 v[86:87], v13 offset:20992
    ds_read_b64_tr_b16 v[88:89], v13 offset:16392
    ds_read_b64_tr_b16 v[90:91], v13 offset:16904
    ds_read_b64_tr_b16 v[92:93], v13 offset:20488
    ds_read_b64_tr_b16 v[94:95], v13 offset:21000
    v_mfma_f32_16x16x32_bf16 v[240:243], v[96:99], v[224:227], 0
    v_mfma_f32_16x16x32_bf16 v[244:247], v[104:107], v[224:227], 0
    v_mfma_f32_16x16x32_bf16 v[248:251], v[96:99], v[232:235], 0
    v_mfma_f32_16x16x32_bf16 v[252:255], v[104:107], v[232:235], 0
    v_mfma_f32_16x16x32_bf16 v[240:243], v[100:103], v[228:231], v[240:243]
    v_mfma_f32_16x16x32_bf16 v[244:247], v[108:111], v[228:231], v[244:247]
    v_mfma_f32_16x16x32_bf16 v[248:251], v[100:103], v[236:239], v[248:251]
    v_mfma_f32_16x16x32_bf16 v[252:255], v[108:111], v[236:239], v[252:255]
    s_branch L_qr
L_tcheck:
    v_max3_i32 v3, v176, v177, v178
    v_max_i32 v3, v3, v179
    v_cmp_le_i32 vcc, 0, v3
    s_or_b64 vcc, vcc, s[44:45]
    s_cbranch_vccnz L_tfail
    v_add_u32 v180, v176, v9
    v_add_u32 v181, v177, v9
    v_add_u32 v182, v178, v9
    v_add_u32 v183, v179, v9
    v_cmp_le_u32 vcc, 0x84800000, v3
    s_cbranch_vccz L2_noextra
    v_max3_i32 v2, v176, v177, v178
    v_med3_i32 v160, v176, v177, v178
    v_med3_i32 v2, v2, v160, v179
    v_subrev_u32 v160, 0x3ffff80, v3
    v_max_u32 v2, v2, v160
    v_cmp_le_u32 vcc, 0x84800000, v2
    v_add_u32 v2, v160, v9
    v_and_b32 v2, s50, v2
    s_cbranch_vccnz L2_extra
    s_mov_b32 s36, 4
    buffer_load_dwordx4 v[160:163], v2, s[8:11], 0 offen sc1
L2_noextra:
    v_and_b32 v180, s50, v180
    buffer_load_dwordx4 v[144:147], v180, s[8:11], 0 offen sc1
    v_and_b32 v181, s50, v181
    buffer_load_dwordx4 v[148:151], v181, s[8:11], 0 offen sc1
    v_and_b32 v182, s50, v182
    buffer_load_dwordx4 v[152:155], v182, s[8:11], 0 offen sc1
    v_and_b32 v183, s50, v183
    buffer_load_dwordx4 v[156:159], v183, s[8:11], 0 offen sc1
    v_mov_b32 v3, -1
    buffer_store_dword v3, v3, s[8:11], 0 offen
    s_cmp_eq_u32 s83, 1
    s_cbranch_scc1 L_after
    s_mov_b32 s83, 2
L_qr:
    v_cmp_eq_u32 vcc, 0, v33
    v_mov_b32 v42, 0
    v_mov_b32 v45, 0
    v_mov_b32 v46, 0
    s_waitcnt lgkmcnt(0)
    v_mfma_f32_16x16x32_bf16 v[128:131], v[80:83], v[224:227], 0
    v_mfma_f32_16x16x32_bf16 v[132:135], v[88:91], v[224:227], 0
    v_mfma_f32_16x16x32_bf16 v[136:139], v[80:83], v[232:235], 0
    v_mfma_f32_16x16x32_bf16 v[140:143], v[88:91], v[232:235], 0
    v_mfma_f32_16x16x32_bf16 v[128:131], v[84:87], v[228:231], v[128:131]
    v_mfma_f32_16x16x32_bf16 v[132:135], v[92:95], v[228:231], v[132:135]
    v_mfma_f32_16x16x32_bf16 v[136:139], v[84:87], v[236:239], v[136:139]
    v_mfma_f32_16x16x32_bf16 v[140:143], v[92:95], v[236:239], v[140:143]
    v_pk_mul_f32 v[240:241], v[240:241], s[58:59]
    v_pk_mul_f32 v[242:243], v[242:243], s[58:59]
    v_pk_mul_f32 v[244:245], v[244:245], s[58:59]
    v_pk_mul_f32 v[246:247], v[246:247], s[58:59]
    s_mov_b64 exec, s[60:61]
    ds_write_b128 v26, v[240:243] offset:0
    ds_write_b128 v26, v[244:247] offset:16
    s_mov_b64 exec, -1
    v_pk_mul_f32 v[248:249], v[248:249], s[58:59]
    v_pk_mul_f32 v[250:251], v[250:251], s[58:59]
    v_pk_mul_f32 v[252:253], v[252:253], s[58:59]
    v_pk_mul_f32 v[254:255], v[254:255], s[58:59]
    s_mov_b64 exec, s[62:63]
    ds_write_b128 v26, v[248:251] offset:4352
    ds_write_b128 v26, v[252:255] offset:4368
    s_mov_b64 exec, -1
    v_lshlrev_b32 v2, 16, v200
    v_mul_f32 v2, s58, v2
    v_cvt_pk_bf16_f32 v3, v41, v2
    v_sub_f32 v2, v2, v3
    v_cvt_pk_bf16_f32 v2, v41, v2
    v_cndmask_b32 v40, v2, v3, vcc
    v_cndmask_b32 v43, v2, v3, vcc
    v_lshlrev_b32 v2, 16, v201
    v_mul_f32 v2, s58, v2
    v_cvt_pk_bf16_f32 v3, v41, v2
    v_sub_f32 v2, v2, v3
    v_cvt_pk_bf16_f32 v2, v41, v2
    v_cndmask_b32 v44, v2, v3, vcc
    v_cndmask_b32 v47, v2, v3, vcc
    v_pk_mul_f32 v[128:129], v[128:129], s[58:59]
    v_pk_mul_f32 v[130:131], v[130:131], s[58:59]
    s_branch L_over3
L_pad3:
    s_branch L_back7
L_over3:
    v_pk_mul_f32 v[132:133], v[132:133], s[58:59]
    v_pk_mul_f32 v[134:135], v[134:135], s[58:59]
    s_mov_b64 exec, s[60:61]
    ds_write_b128 v26, v[128:131] offset:26752
    ds_write_b128 v26, v[132:135] offset:26768
    s_mov_b64 exec, -1
    v_pk_mul_f32 v[136:137], v[136:137], s[58:59]
    v_pk_mul_f32 v[138:139], v[138:139], s[58:59]
    v_pk_mul_f32 v[140:141], v[140:141], s[58:59]
    v_pk_mul_f32 v[142:143], v[142:143], s[58:59]
    s_mov_b64 exec, s[62:63]
    ds_write_b128 v26, v[136:139] offset:31104
    ds_write_b128 v26, v[140:143] offset:31120
    s_mov_b64 exec, -1
    v_mov_b64 v[112:113], -1
    v_mov_b64 v[114:115], -1
    v_mov_b64 v[116:117], -1
    v_mov_b64 v[118:119], -1
    v_mov_b64 v[120:121], -1
    v_mov_b64 v[122:123], -1
    buffer_load_dword v176, v8, s[8:11], s47 offen offset:0 sc1
    buffer_load_dword v177, v8, s[8:11], s47 offen offset:128 sc1
    buffer_load_dword v178, v8, s[8:11], s47 offen offset:256 sc1
    buffer_load_dword v179, v8, s[8:11], s47 offen offset:384 sc1
    v_mov_b32 v2, 1
    v_mov_b32 v3, 592
    s_lshl_b32 s3, s2, 4
    s_mov_b64 exec, 1
    s_waitcnt vmcnt(4)
    ds_add_rtn_u32 v3, v3, v2
    s_add_u32 s3, s3, 2421424128
    s_mov_b32 s51, 32048
    s_waitcnt lgkmcnt(0)
    v_lshl_add_u32 v3, v3, 28, s3
    buffer_store_dword v2, v3, s[8:11], 0 offen sc1
    s_mov_b64 exec, -1
    s_cmp_lg_u32 s83, 2
    s_cbranch_scc1 L_tfail1
L_after:
    v_mov_b32 v2, 4
    s_cmp_eq_u32 s36, 0
    s_cbranch_scc1 L2_pl
    s_cmp_lg_u32 s36, 4
    s_cbranch_scc1 L2_xpl
    v_mov_b64 v[164:165], -1
    v_mov_b32 v166, -1
    s_waitcnt vmcnt(5)
    v_lshlrev_b32_sdwa v168, 2, v163 dst_sel:DWORD dst_unused:UNUSED_PAD src0_sel:DWORD src1_sel:BYTE_0
    v_lshlrev_b32_sdwa v169, 2, v163 dst_sel:DWORD dst_unused:UNUSED_PAD src0_sel:DWORD src1_sel:BYTE_1
    v_lshlrev_b32_sdwa v170, 2, v163 dst_sel:DWORD dst_unused:UNUSED_PAD src0_sel:DWORD src1_sel:BYTE_2
    v_cmpx_ne_u32 vcc, 0, v168
    ds_add_rtn_u32 v164, v168, v2 offset:0
    v_cmpx_ne_u32 vcc, 0, v169
    ds_add_rtn_u32 v165, v169, v2 offset:0
    v_cmpx_ne_u32 vcc, 0, v170
    ds_add_rtn_u32 v166, v170, v2 offset:0
    s_mov_b64 exec, -1
L2_pl:
    s_waitcnt vmcnt(4)
    v_lshlrev_b32_sdwa v124, 2, v147 dst_sel:DWORD dst_unused:UNUSED_PAD src0_sel:DWORD src1_sel:BYTE_0
    v_lshlrev_b32_sdwa v125, 2, v147 dst_sel:DWORD dst_unused:UNUSED_PAD src0_sel:DWORD src1_sel:BYTE_1
    v_lshlrev_b32_sdwa v126, 2, v147 dst_sel:DWORD dst_unused:UNUSED_PAD src0_sel:DWORD src1_sel:BYTE_2
    v_cmpx_ne_u32 vcc, 0, v124
    ds_add_rtn_u32 v112, v124, v2 offset:0
    v_cmpx_ne_u32 vcc, 0, v125
    ds_add_rtn_u32 v113, v125, v2 offset:0
    v_cmpx_ne_u32 vcc, 0, v126
    ds_add_rtn_u32 v114, v126, v2 offset:0
    s_mov_b64 exec, -1
    s_waitcnt vmcnt(3)
    v_lshlrev_b32_sdwa v127, 2, v151 dst_sel:DWORD dst_unused:UNUSED_PAD src0_sel:DWORD src1_sel:BYTE_0
    v_lshlrev_b32_sdwa v128, 2, v151 dst_sel:DWORD dst_unused:UNUSED_PAD src0_sel:DWORD src1_sel:BYTE_1
    v_lshlrev_b32_sdwa v129, 2, v151 dst_sel:DWORD dst_unused:UNUSED_PAD src0_sel:DWORD src1_sel:BYTE_2
    v_cmpx_ne_u32 vcc, 0, v127
    ds_add_rtn_u32 v115, v127, v2 offset:0
    v_cmpx_ne_u32 vcc, 0, v128
    ds_add_rtn_u32 v116, v128, v2 offset:0
    v_cmpx_ne_u32 vcc, 0, v129
    ds_add_rtn_u32 v117, v129, v2 offset:0
    s_mov_b64 exec, -1
    s_waitcnt vmcnt(2) lgkmcnt(0)
    v_lshlrev_b32_sdwa v130, 2, v155 dst_sel:DWORD dst_unused:UNUSED_PAD src0_sel:DWORD src1_sel:BYTE_0
    v_lshlrev_b32_sdwa v131, 2, v155 dst_sel:DWORD dst_unused:UNUSED_PAD src0_sel:DWORD src1_sel:BYTE_1
    v_lshlrev_b32_sdwa v132, 2, v155 dst_sel:DWORD dst_unused:UNUSED_PAD src0_sel:DWORD src1_sel:BYTE_2
    v_cmpx_ne_u32 vcc, 0, v130
    ds_add_rtn_u32 v118, v130, v2 offset:0
    v_cmpx_ne_u32 vcc, 0, v131
    ds_add_rtn_u32 v119, v131, v2 offset:0
    v_cmpx_ne_u32 vcc, 0, v132
    ds_add_rtn_u32 v120, v132, v2 offset:0
    s_mov_b64 exec, -1
    v_cmpx_gt_u32 vcc, s51, v112
    ds_write_b32 v112, v144
    v_cmpx_gt_u32 vcc, s51, v113
    ds_write_b32 v113, v145
    v_cmpx_gt_u32 vcc, s51, v114
    ds_write_b32 v114, v146
    s_mov_b64 exec, -1
    v_cmpx_gt_u32 vcc, s51, v115
    ds_write_b32 v115, v148
    v_cmpx_gt_u32 vcc, s51, v116
    ds_write_b32 v116, v149
    v_cmpx_gt_u32 vcc, s51, v117
    ds_write_b32 v117, v150
    s_mov_b64 exec, -1
    ds_read_u16 v55, v54 offset:6144
    s_waitcnt vmcnt(1)
    v_lshlrev_b32_sdwa v133, 2, v159 dst_sel:DWORD dst_unused:UNUSED_PAD src0_sel:DWORD src1_sel:BYTE_0
    v_lshlrev_b32_sdwa v134, 2, v159 dst_sel:DWORD dst_unused:UNUSED_PAD src0_sel:DWORD src1_sel:BYTE_1
    v_lshlrev_b32_sdwa v135, 2, v159 dst_sel:DWORD dst_unused:UNUSED_PAD src0_sel:DWORD src1_sel:BYTE_2
    v_cmpx_ne_u32 vcc, 0, v133
    ds_add_rtn_u32 v121, v133, v2 offset:0
    v_cmpx_ne_u32 vcc, 0, v134
    ds_add_rtn_u32 v122, v134, v2 offset:0
    v_cmpx_ne_u32 vcc, 0, v135
    ds_add_rtn_u32 v123, v135, v2 offset:0
    s_mov_b64 exec, -1
    s_waitcnt lgkmcnt(0)
    buffer_load_dword v64, v55, s[4:7], 0 idxen offset:3072 sc1
    buffer_load_dword v64, v55, s[4:7], 0 idxen offset:3136 sc1
    v_cmpx_gt_u32 vcc, s51, v118
    ds_write_b32 v118, v152
    v_cmpx_gt_u32 vcc, s51, v119
    ds_write_b32 v119, v153
    v_cmpx_gt_u32 vcc, s51, v120
    ds_write_b32 v120, v154
    s_mov_b64 exec, -1
    v_cmpx_gt_u32 vcc, s51, v121
    ds_write_b32 v121, v156
    v_cmpx_gt_u32 vcc, s51, v122
    ds_write_b32 v122, v157
    v_cmpx_gt_u32 vcc, s51, v123
    ds_write_b32 v123, v158
    s_mov_b64 exec, -1
    s_cmp_lg_u32 s36, 4
    s_cbranch_scc1 L2_build
    v_cmpx_gt_u32 vcc, s51, v164
    ds_write_b32 v164, v160
    v_cmpx_gt_u32 vcc, s51, v165
    ds_write_b32 v165, v161
    v_cmpx_gt_u32 vcc, s51, v166
    ds_write_b32 v166, v162
    s_mov_b64 exec, -1
L2_build:
    v_lshlrev_b32 v208, 2, v1
    s_mov_b32 s3, 260
    v_mov_b32 v209, 6140
    v_mad_u32_u24 v209, v1, s3, v209
    v_add_u32 v210, 4, v209
    v_add_u32 v211, 0x4100, v210
    s_cmp_lt_u32 s16, 168
    s_cselect_b32 s33, 3, 1
    s_mov_b32 s32, -1
    s_mov_b32 s35, 0
    s_mov_b32 s31, 0
    v_mov_b32 v218, 31624
    s_lshl_b32 s3, s17, 6
    v_and_b32 v3, 60, v208
    v_add_u32 v34, s3, v3
    v_mov_b32 v2, 0xfe000000
    ds_write_b32 v34, v2 offset:1136
    v_mov_b32 v214, 0
    v_add_u32 v3, 16640, v209
    s_mov_b32 s42, 0x100401
    s_waitcnt lgkmcnt(0)
    s_barrier
    global_load_dword v176, v38, s[80:81] offset:0 sc1
    global_load_dword v177, v38, s[80:81] offset:1024 sc1
    global_load_dword v178, v38, s[80:81] offset:2048 sc1
    global_load_dword v179, v38, s[80:81] offset:3072 sc1
    ds_read_b32 v212, v208 offset:4
    ds_read_b32 v213, v208 offset:260
    ds_read_b32 v214, v214 offset:584
    s_branch L_over4
L_pad4:
    s_branch L_back7
L_over4:
    ds_write_b32 v35, v218
    s_waitcnt lgkmcnt(2)
    v_sub_u32 v212, v212, v209
    v_sub_u32 v213, v213, v3
    v_lshlrev_b32 v212, 3, v212
    v_lshlrev_b32 v213, 3, v213
    ds_read_b128 v[148:151], v212 offset:2064
    ds_read_b128 v[156:159], v213 offset:2064
    ds_read_b128 v[144:147], v212 offset:2048
    ds_read_b128 v[152:155], v213 offset:2048
    v_max_u32 v2, v212, v213
    v_cmp_lt_u32 vcc, 2016, v2
    s_waitcnt lgkmcnt(4)
    v_cmp_lt_u32_e64 s[40:41], 1, v214
    s_or_b64 vcc, vcc, s[40:41]
    s_cbranch_vccnz L2_slow
L2_scan:
    s_waitcnt lgkmcnt(2)
    v_add_u32 v218, v148, v156
    v_add_u32 v219, v149, v157
    v_mov_b32 v216, v218
    v_mov_b32 v217, v219
    s_waitcnt lgkmcnt(0)
    v_add_u32 v144, v144, v210
    v_add_u32_dpp v216, v216, v216 row_shr:1 row_mask:0xf bank_mask:0xf
    v_add_u32_dpp v217, v217, v217 row_shr:1 row_mask:0xf bank_mask:0xf
    v_add_u32 v145, v145, v210
    v_add_u32_dpp v216, v216, v216 row_shr:2 row_mask:0xf bank_mask:0xf
    v_add_u32_dpp v217, v217, v217 row_shr:2 row_mask:0xf bank_mask:0xf
    v_add_u32 v146, v146, v210
    v_add_u32_dpp v216, v216, v216 row_shr:4 row_mask:0xf bank_mask:0xf
    v_add_u32_dpp v217, v217, v217 row_shr:4 row_mask:0xf bank_mask:0xf
    v_add_u32 v147, v147, v210
    v_add_u32_dpp v216, v216, v216 row_shr:8 row_mask:0xf bank_mask:0xf
    v_add_u32_dpp v217, v217, v217 row_shr:8 row_mask:0xf bank_mask:0xf
    v_add_u32 v152, v152, v211
    v_add_u32_dpp v216, v216, v216 row_bcast:15 row_mask:0xa bank_mask:0xf
    v_add_u32_dpp v217, v217, v217 row_bcast:15 row_mask:0xa bank_mask:0xf
    v_add_u32 v153, v153, v211
    v_add_u32_dpp v216, v216, v216 row_bcast:31 row_mask:0xc bank_mask:0xf
    v_add_u32_dpp v217, v217, v217 row_bcast:31 row_mask:0xc bank_mask:0xf
    v_add_u32 v154, v154, v211
    v_add_u32 v155, v155, v211
    v_readlane_b32 s44, v216, 63
    v_readlane_b32 s45, v217, 63
    v_sub_u32 v216, v216, v218
    v_sub_u32 v217, v217, v219
    s_mul_i32 s44, s44, s42
    s_mul_i32 s45, s45, s42
    s_bfe_u32 s46, s44, 0xa0014
    s_bfe_u32 s47, s45, 0xa0014
    s_lshl_b32 s44, s44, 10
    s_lshl_b32 s45, s45, 10
    s_add_u32 s47, s47, s46
    s_mul_i32 s46, s46, s42
    v_add_u32 v216, s44, v216
    s_add_u32 s45, s45, s46
    s_cmp_gt_u32 s47, 256
    s_cbranch_scc1 L2_retry
    v_add_u32 v217, s45, v217
    v_lshrrev_b64 v[218:219], v150, v[216:217]
    v_add_u32 v216, v216, v148
    v_add_u32 v217, v217, v149
    v_and_b32 v2, 0x1ff, v218
    v_lshrrev_b64 v[218:219], v158, v[216:217]
    v_lshl_add_u32 v2, v2, 2, s19
    ds_write2_b32 v2, v146, v147 offset0:2 offset1:3
    v_and_b32 v3, 0x1ff, v218
    v_lshl_add_u32 v3, v3, 2, s19
    s_mov_b64 exec, s[32:33]
    ds_write2_b32 v3, v154, v155 offset0:2 offset1:3
    ds_write2_b32 v3, v152, v153 offset0:0 offset1:1
    s_mov_b64 exec, -1
    ds_write2_b32 v2, v144, v145 offset0:0 offset1:1
    s_lshl_b32 s3, s18, 7
    s_add_u32 s3, s3, s19
    v_lshrrev_b32 v2, 3, v1
    v_lshl_add_u32 v2, v2, 2, s3
    ds_read_b32 v8, v2 offset:0
    ds_read_b32 v9, v2 offset:32
    ds_read_b32 v10, v2 offset:64
    ds_read_b32 v11, v2 offset:96
    ds_read_b32 v31, v35
    s_mov_b32 s6, 25088
    s_mov_b32 m0, s19
    s_mov_b32 s3, 272
    v_lshlrev_b32 v3, 5, v33
    s_mov_b32 s40, 0xffff
    s_waitcnt lgkmcnt(4)
    v_and_b32 v76, s40, v8
    ds_read_u16 v16, v76 offset:0
    s_waitcnt lgkmcnt(4)
    v_and_b32 v77, s40, v9
    ds_read_u16 v18, v77 offset:0
    s_waitcnt lgkmcnt(4)
    v_and_b32 v78, s40, v10
    ds_read_u16 v20, v78 offset:0
    s_waitcnt lgkmcnt(4)
    v_and_b32 v79, s40, v11
    ds_read_u16 v22, v79 offset:0
    v_lshrrev_b32 v8, 25, v8
    v_lshl_add_u32 v8, v8, 2, v76
    v_lshrrev_b32 v9, 25, v9
    v_lshl_add_u32 v9, v9, 2, v77
    v_lshrrev_b32 v10, 25, v10
    v_lshl_add_u32 v10, v10, 2, v78
    v_lshrrev_b32 v11, 25, v11
    v_lshl_add_u32 v11, v11, 2, v79
    s_waitcnt lgkmcnt(4)
    v_and_b32 v53, s40, v31
    v_lshrrev_b32 v2, 25, v31
    v_lshl_add_u32 v12, v2, 2, v53
    v_subrev_u32 v2, 6080, v53
    v_mul_u32_u24 v2, 16132, v2
    v_bfe_u32 v13, v31, 16, 6
    v_lshrrev_b32 v2, 22, v2
    v_and_b32 v31, 0x01c00000, v31
    v_lshl_or_b32 v31, v2, 25, v31
    v_or_b32 v31, v31, v12
    v_mad_u32_u24 v28, v2, s3, v3
    v_add_u32 v28, 110080, v28
    s_waitcnt vmcnt(0)
L_pf_check:
    v_and_b32 v2, v176, v177
    v_and_b32 v2, v2, v178
    v_and_b32 v2, v2, v179
    v_cmp_ne_u32 vcc, 1, v2
    s_cbranch_vccnz L_pf_again
L_pf_ok:
    s_waitcnt lgkmcnt(3)
    buffer_load_dwordx4 v[16:17], s[4:7], 0 idxen offen offset:0 sc1 lds
    s_waitcnt lgkmcnt(2)
    buffer_load_dwordx4 v[18:19], s[4:7], 0 idxen offen offset:1024 sc1 lds
    s_waitcnt lgkmcnt(1)
    buffer_load_dwordx4 v[20:21], s[4:7], 0 idxen offen offset:2048 sc1 lds
    s_waitcnt lgkmcnt(0)
    buffer_load_dwordx4 v[22:23], s[4:7], 0 idxen offen offset:3072 sc1 lds
    ds_read_u16 v16, v8 offset:4
    ds_read_u16 v18, v9 offset:4
    ds_read_u16 v20, v10 offset:4
    ds_read_u16 v22, v11 offset:4
    ds_read_b32 v24, v53
    ds_read_b32 v25, v12 offset:4
    ds_read_b128 v[80:83], v28 offset:0
    ds_read_b128 v[84:87], v28 offset:16
    ds_read_b128 v[88:91], v28 offset:64
    ds_read_b128 v[92:95], v28 offset:80
    ds_read_b128 v[96:99], v28 offset:128
    ds_read_b128 v[100:103], v28 offset:144
    ds_read_b128 v[104:107], v28 offset:192
    ds_read_b128 v[108:111], v28 offset:208
    v_bfe_u32 v36, v31, 22, 3
    v_mov_b32 v37, v13
    v_cmp_ne_u32 vcc, 0, v36
    v_add_u32 v2, 26752, v28
    v_add_u32 v27, 608, v3
    v_cndmask_b32 v27, v27, v2, vcc
    v_mbcnt_lo_u32_b32 v2, vcc_lo, 0
    s_lshl_b32 s40, s17, 6
    v_lshl_add_u32 v2, v2, 2, s40
    s_mov_b32 s41, 0xffc00000
    v_and_or_b32 v29, v31, s41, v32
    s_mov_b32 m0, s37
    s_waitcnt lgkmcnt(10)
    buffer_load_dwordx4 v[16:17], s[4:7], 0 idxen offen offset:0 sc1 lds
    buffer_load_dwordx4 v[18:19], s[4:7], 0 idxen offen offset:1024 sc1 lds
    buffer_load_dwordx4 v[20:21], s[4:7], 0 idxen offen offset:2048 sc1 lds
    buffer_load_dwordx4 v[22:23], s[4:7], 0 idxen offen offset:3072 sc1 lds
    s_branch L_over5
L_pad5:
    s_branch L_back7
L_over5:
    ds_read_u16 v16, v8 offset:8
    ds_read_u16 v18, v9 offset:8
    ds_read_u16 v20, v10 offset:8
    ds_read_u16 v22, v11 offset:8
    s_mov_b32 exec_lo, vcc_lo
    s_mov_b32 exec_hi, 0
    ds_write_b32 v2, v29 offset:1136
    s_mov_b64 exec, -1
    v_and_b32 v2, 60, v1
    v_add_u32 v2, s40, v2
    ds_read_b32 v29, v2 offset:1136
    v_add_u32 v2, v36, v32
    v_cmp_lt_u32 vcc, 32, v2
    v_mad_u32_u24 v26, v32, s3, v3
    v_add_u32 v26, s19, v26
    s_cmp_lg_u64 vcc, 0
    s_cselect_b32 s34, 1, 0
    s_cmp_lg_u32 s18, 7
    s_cselect_b32 s34, s34, 0
    v_cmp_lt_u32_e64 s[28:29], 0, v13
    v_cmp_lt_u32_e64 s[26:27], 1, v13
    v_max_u32_dpp v37, v37, v37 row_shr:1 row_mask:0xf bank_mask:0xf
    v_mov_b32 v14, 0
    v_mov_b32 v15, 0
    v_max_u32_dpp v37, v37, v37 row_shr:2 row_mask:0xf bank_mask:0xf
    s_nop 1
    v_max_u32_dpp v37, v37, v37 row_shr:4 row_mask:0xf bank_mask:0xf
    s_nop 1
    v_max_u32_dpp v37, v37, v37 row_shr:8 row_mask:0xf bank_mask:0xf
    s_nop 1
    v_max_u32_dpp v37, v37, v37 row_bcast:15 row_mask:0xa bank_mask:0xf
    s_nop 1
    v_max_u32_dpp v37, v37, v37 row_bcast:31 row_mask:0xc bank_mask:0xf
    s_nop 0
    v_readlane_b32 s20, v37, 63
    s_mov_b32 s21, 1
    s_waitcnt vmcnt(4)
    ds_read_b128 v[224:227], v4 offset:0
    ds_read_b128 v[228:231], v5 offset:0
    ds_read_b128 v[232:235], v6 offset:0
    ds_read_b128 v[236:239], v7 offset:0
    s_max_u32 s20, s20, 2
    s_sub_u32 s83, s20, 2
    s_cmp_lt_u32 s17, 4
    s_cselect_b32 s83, s83, -1
    s_setprio 1
    s_cmp_gt_u32 s20, 2
    s_cselect_b32 s6, 25088, 0
    s_mov_b32 m0, s19
    s_waitcnt lgkmcnt(4)
    v_mfma_f32_32x32x8_bf16 v[144:159], v[40:41], v[24:25], v[80:95]
    s_waitcnt lgkmcnt(0)
    v_smfmac_f32_32x32x32_bf16 v[144:159], v[48:51], v[224:231], v52
    buffer_load_dwordx4 v[16:17], s[4:7], 0 idxen offen offset:0 sc1 lds
    buffer_load_dwordx4 v[18:19], s[4:7], 0 idxen offen offset:1024 sc1 lds
    buffer_load_dwordx4 v[20:21], s[4:7], 0 idxen offen offset:2048 sc1 lds
    buffer_load_dwordx4 v[22:23], s[4:7], 0 idxen offen offset:3072 sc1 lds
    s_nop 6
    v_mfma_f32_32x32x8_bf16 v[160:175], v[44:45], v[24:25], v[96:111]
    v_exp_f32 v208, v144
    v_exp_f32 v209, v145
    v_exp_f32 v210, v146
    v_exp_f32 v211, v147
    v_smfmac_f32_32x32x32_bf16 v[160:175], v[48:51], v[232:239], v52
    v_exp_f32 v212, v148
    v_exp_f32 v213, v149
    v_exp_f32 v214, v150
    v_exp_f32 v215, v151
    v_exp_f32 v216, v152
    v_exp_f32 v217, v153
    v_exp_f32 v218, v154
    v_exp_f32 v219, v155
    v_exp_f32 v220, v156
    v_exp_f32 v221, v157
    v_exp_f32 v222, v158
    v_exp_f32 v223, v159
    s_waitcnt vmcnt(4)
    ds_read_b128 v[240:243], v4 offset:4096
    ds_read_b128 v[244:247], v5 offset:4096
    ds_read_b128 v[248:251], v6 offset:4096
    ds_read_b128 v[252:255], v7 offset:4096
    ds_read_u16 v16, v8 offset:12
    ds_read_u16 v18, v9 offset:12
    ds_read_u16 v20, v10 offset:12
    ds_read_u16 v22, v11 offset:12
    v_pk_add_f32 v[176:177], v[208:209], s[22:23]
    v_pk_add_f32 v[178:179], v[210:211], s[22:23]
    v_pk_add_f32 v[180:181], v[212:213], s[22:23]
    v_pk_add_f32 v[182:183], v[214:215], s[22:23]
    v_pk_add_f32 v[184:185], v[216:217], s[22:23]
    v_pk_add_f32 v[186:187], v[218:219], s[22:23]
    v_pk_add_f32 v[188:189], v[220:221], s[22:23]
    v_pk_add_f32 v[190:191], v[222:223], s[22:23]
    s_cmp_gt_u32 s20, 3
    s_cselect_b32 s6, 25088, 0
    s_mov_b32 m0, s37
    s_waitcnt lgkmcnt(0)
    v_mfma_f32_32x32x8_bf16 v[112:127], v[42:43], v[24:25], v[80:95]
    v_exp_f32 v208, v160
    v_exp_f32 v209, v161
    v_exp_f32 v210, v162
    v_exp_f32 v211, v163
    v_smfmac_f32_32x32x32_bf16 v[112:127], v[48:51], v[240:247], v52
    v_exp_f32 v212, v164
    v_exp_f32 v213, v165
    v_exp_f32 v214, v166
    v_exp_f32 v215, v167
    v_exp_f32 v216, v168
    v_exp_f32 v217, v169
    v_exp_f32 v218, v170
    v_exp_f32 v219, v171
    v_exp_f32 v220, v172
    v_exp_f32 v221, v173
    v_exp_f32 v222, v174
    v_exp_f32 v223, v175
    buffer_load_dwordx4 v[16:17], s[4:7], 0 idxen offen offset:0 sc1 lds
    buffer_load_dwordx4 v[18:19], s[4:7], 0 idxen offen offset:1024 sc1 lds
    buffer_load_dwordx4 v[20:21], s[4:7], 0 idxen offen offset:2048 sc1 lds
    buffer_load_dwordx4 v[22:23], s[4:7], 0 idxen offen offset:3072 sc1 lds
    v_pk_add_f32 v[192:193], v[208:209], s[22:23]
    v_pk_add_f32 v[194:195], v[210:211], s[22:23]
    v_pk_add_f32 v[196:197], v[212:213], s[22:23]
    v_pk_add_f32 v[198:199], v[214:215], s[22:23]
    v_pk_add_f32 v[200:201], v[216:217], s[22:23]
    v_pk_add_f32 v[202:203], v[218:219], s[22:23]
    v_pk_add_f32 v[204:205], v[220:221], s[22:23]
    v_pk_add_f32 v[206:207], v[222:223], s[22:23]
    s_branch L2_loop
L_tfail:
    v_cmp_le_i32 vcc, 0, v176
    s_mov_b64 exec, vcc
    buffer_load_dword v176, v8, s[8:11], s47 offen offset:0 sc1
    s_mov_b64 exec, -1
    v_cmp_le_i32 vcc, 0, v177
    s_mov_b64 exec, vcc
    buffer_load_dword v177, v8, s[8:11], s47 offen offset:128 sc1
    s_mov_b64 exec, -1
    v_cmp_le_i32 vcc, 0, v178
    s_mov_b64 exec, vcc
    buffer_load_dword v178, v8, s[8:11], s47 offen offset:256 sc1
    s_mov_b64 exec, -1
    v_cmp_le_i32 vcc, 0, v179
    s_mov_b64 exec, vcc
    buffer_load_dword v179, v8, s[8:11], s47 offen offset:384 sc1
    s_mov_b64 exec, -1
    s_cmp_eq_u32 s83, 0
    s_cbranch_scc1 L_qr
    s_sub_u32 s39, s39, 1
    s_cbranch_scc1 L_timeout
L_tback:
    s_sleep 4
    s_waitcnt vmcnt(4)
    s_branch L_tcheck
L_tfail1:
    s_mov_b32 s83, 1
    s_cmp_lg_u64 s[44:45], 0
    s_cbranch_scc1 L2_build
    s_branch L_padt
L_pf_again:
    s_sub_u32 s82, s82, 1
    s_cselect_b32 s82, 0, s82
    s_cbranch_scc1 L_pf_ok
    s_sleep 1
    global_load_dword v176, v38, s[80:81] offset:0 sc1
    global_load_dword v177, v38, s[80:81] offset:1024 sc1
    global_load_dword v178, v38, s[80:81] offset:2048 sc1
    global_load_dword v179, v38, s[80:81] offset:3072 sc1
    s_waitcnt vmcnt(0)
    s_branch L_pf_check
.p2align 12
L_pad6:
    s_branch L_back7
L_padt:
    s_waitcnt vmcnt(1)
    s_branch L_tcheck
.p2align 6
L2_loop:
    v_mfma_f32_32x32x8_bf16 v[128:143], v[46:47], v[24:25], v[96:111]
    v_exp_f32 v208, v112
    v_exp_f32 v209, v113
    v_exp_f32 v210, v114
    v_exp_f32 v211, v115
    v_smfmac_f32_32x32x32_bf16 v[128:143], v[48:51], v[248:255], v52
    v_exp_f32 v212, v116
    v_exp_f32 v213, v117
    v_exp_f32 v214, v118
    v_exp_f32 v215, v119
    v_exp_f32 v216, v120
    v_exp_f32 v217, v121
    v_exp_f32 v218, v122
    v_exp_f32 v219, v123
    v_exp_f32 v220, v124
    v_exp_f32 v221, v125
    v_exp_f32 v222, v126
    v_exp_f32 v223, v127
    s_add_u32 s21, s21, 1
    s_waitcnt vmcnt(4)
    ds_read_b128 v[224:227], v4 offset:0
    ds_read_b128 v[228:231], v5 offset:0
    ds_read_b128 v[232:235], v6 offset:0
    ds_read_b128 v[236:239], v7 offset:0
    ds_read_u16 v16, v8 offset:16
    ds_read_u16 v18, v9 offset:16
    ds_read_u16 v20, v10 offset:16
    ds_read_u16 v22, v11 offset:16
    ds_read2_b32 v[24:25], v12 offset0:2 offset1:3
    s_cmp_ge_u32 s21, s20
    s_mov_b64 exec, s[26:27]
    v_pk_fma_f32 v[144:145], v[144:145], v[208:209], v[144:145]
    v_pk_fma_f32 v[146:147], v[146:147], v[210:211], v[146:147]
    v_pk_fma_f32 v[148:149], v[148:149], v[212:213], v[148:149]
    v_pk_fma_f32 v[150:151], v[150:151], v[214:215], v[150:151]
    v_pk_fma_f32 v[152:153], v[152:153], v[216:217], v[152:153]
    v_pk_fma_f32 v[154:155], v[154:155], v[218:219], v[154:155]
    v_pk_fma_f32 v[156:157], v[156:157], v[220:221], v[156:157]
    v_pk_fma_f32 v[158:159], v[158:159], v[222:223], v[158:159]
    v_pk_fma_f32 v[144:145], v[112:113], v[176:177], v[144:145]
    v_pk_fma_f32 v[146:147], v[114:115], v[178:179], v[146:147]
    v_pk_fma_f32 v[148:149], v[116:117], v[180:181], v[148:149]
    v_pk_fma_f32 v[150:151], v[118:119], v[182:183], v[150:151]
    v_pk_fma_f32 v[152:153], v[120:121], v[184:185], v[152:153]
    v_pk_fma_f32 v[154:155], v[122:123], v[186:187], v[154:155]
    v_pk_fma_f32 v[156:157], v[124:125], v[188:189], v[156:157]
    v_pk_fma_f32 v[158:159], v[126:127], v[190:191], v[158:159]
    v_pk_fma_f32 v[176:177], v[176:177], v[208:209], v[176:177]
    v_pk_fma_f32 v[178:179], v[178:179], v[210:211], v[178:179]
    v_pk_fma_f32 v[180:181], v[180:181], v[212:213], v[180:181]
    v_pk_fma_f32 v[182:183], v[182:183], v[214:215], v[182:183]
    v_pk_fma_f32 v[184:185], v[184:185], v[216:217], v[184:185]
    v_pk_fma_f32 v[186:187], v[186:187], v[218:219], v[186:187]
    v_pk_fma_f32 v[188:189], v[188:189], v[220:221], v[188:189]
    v_pk_fma_f32 v[190:191], v[190:191], v[222:223], v[190:191]
    s_cbranch_scc1 L2_last
    s_mov_b64 exec, -1
    s_cmp_lg_u32 s21, s83
    s_cbranch_scc1 L2_np1
    s_setprio 0
L2_np1:
    s_add_u32 s40, s21, 2
    s_cmp_lt_u32 s40, s20
    s_cselect_b32 s6, 25088, 0
    s_mov_b32 m0, s19
    s_waitcnt lgkmcnt(0)
    v_mfma_f32_32x32x8_bf16 v[112:127], v[40:41], v[24:25], v[80:95]
    v_exp_f32 v208, v128
    v_exp_f32 v209, v129
    v_exp_f32 v210, v130
    v_exp_f32 v211, v131
    v_smfmac_f32_32x32x32_bf16 v[112:127], v[48:51], v[224:231], v52
    v_exp_f32 v212, v132
    v_exp_f32 v213, v133
    v_exp_f32 v214, v134
    v_exp_f32 v215, v135
    v_exp_f32 v216, v136
    v_exp_f32 v217, v137
    v_exp_f32 v218, v138
    v_exp_f32 v219, v139
    v_exp_f32 v220, v140
    v_exp_f32 v221, v141
    v_exp_f32 v222, v142
    v_exp_f32 v223, v143
    v_cmp_lt_u32_e64 s[24:25], s21, v13
    buffer_load_dwordx4 v[16:17], s[4:7], 0 idxen offen offset:0 sc1 lds
    buffer_load_dwordx4 v[18:19], s[4:7], 0 idxen offen offset:1024 sc1 lds
    buffer_load_dwordx4 v[20:21], s[4:7], 0 idxen offen offset:2048 sc1 lds
    buffer_load_dwordx4 v[22:23], s[4:7], 0 idxen offen offset:3072 sc1 lds
    s_mov_b64 exec, s[26:27]
    v_pk_fma_f32 v[160:161], v[160:161], v[208:209], v[160:161]
    v_pk_fma_f32 v[162:163], v[162:163], v[210:211], v[162:163]
    v_pk_fma_f32 v[164:165], v[164:165], v[212:213], v[164:165]
    v_pk_fma_f32 v[166:167], v[166:167], v[214:215], v[166:167]
    v_pk_fma_f32 v[168:169], v[168:169], v[216:217], v[168:169]
    v_pk_fma_f32 v[170:171], v[170:171], v[218:219], v[170:171]
    v_pk_fma_f32 v[172:173], v[172:173], v[220:221], v[172:173]
    v_pk_fma_f32 v[174:175], v[174:175], v[222:223], v[174:175]
    v_pk_fma_f32 v[160:161], v[128:129], v[192:193], v[160:161]
    v_pk_fma_f32 v[162:163], v[130:131], v[194:195], v[162:163]
    v_pk_fma_f32 v[164:165], v[132:133], v[196:197], v[164:165]
    v_pk_fma_f32 v[166:167], v[134:135], v[198:199], v[166:167]
    v_pk_fma_f32 v[168:169], v[136:137], v[200:201], v[168:169]
    v_pk_fma_f32 v[170:171], v[138:139], v[202:203], v[170:171]
    v_pk_fma_f32 v[172:173], v[140:141], v[204:205], v[172:173]
    v_pk_fma_f32 v[174:175], v[142:143], v[206:207], v[174:175]
    v_pk_fma_f32 v[192:193], v[192:193], v[208:209], v[192:193]
    v_pk_fma_f32 v[194:195], v[194:195], v[210:211], v[194:195]
    v_pk_fma_f32 v[196:197], v[196:197], v[212:213], v[196:197]
    v_pk_fma_f32 v[198:199], v[198:199], v[214:215], v[198:199]
    v_pk_fma_f32 v[200:201], v[200:201], v[216:217], v[200:201]
    v_pk_fma_f32 v[202:203], v[202:203], v[218:219], v[202:203]
    v_pk_fma_f32 v[204:205], v[204:205], v[220:221], v[204:205]
    v_pk_fma_f32 v[206:207], v[206:207], v[222:223], v[206:207]
    s_mov_b64 exec, -1
    v_mfma_f32_32x32x8_bf16 v[128:143], v[44:45], v[24:25], v[96:111]
    v_exp_f32 v208, v112
    v_exp_f32 v209, v113
    v_exp_f32 v210, v114
    v_exp_f32 v211, v115
    v_smfmac_f32_32x32x32_bf16 v[128:143], v[48:51], v[232:239], v52
    v_exp_f32 v212, v116
    v_exp_f32 v213, v117
    v_exp_f32 v214, v118
    v_exp_f32 v215, v119
    v_exp_f32 v216, v120
    v_exp_f32 v217, v121
    v_exp_f32 v218, v122
    v_exp_f32 v219, v123
    v_exp_f32 v220, v124
    v_exp_f32 v221, v125
    v_exp_f32 v222, v126
    v_exp_f32 v223, v127
    s_add_u32 s21, s21, 1
    s_waitcnt vmcnt(4)
    ds_read_b128 v[240:243], v4 offset:4096
    ds_read_b128 v[244:247], v5 offset:4096
    ds_read_b128 v[248:251], v6 offset:4096
    ds_read_b128 v[252:255], v7 offset:4096
    ds_read_u16 v16, v8 offset:20
    ds_read_u16 v18, v9 offset:20
    ds_read_u16 v20, v10 offset:20
    ds_read_u16 v22, v11 offset:20
    s_cmp_ge_u32 s21, s20
    s_mov_b64 exec, s[24:25]
    v_pk_fma_f32 v[144:145], v[144:145], v[208:209], v[144:145]
    v_pk_fma_f32 v[146:147], v[146:147], v[210:211], v[146:147]
    v_pk_fma_f32 v[148:149], v[148:149], v[212:213], v[148:149]
    v_pk_fma_f32 v[150:151], v[150:151], v[214:215], v[150:151]
    v_pk_fma_f32 v[152:153], v[152:153], v[216:217], v[152:153]
    v_pk_fma_f32 v[154:155], v[154:155], v[218:219], v[154:155]
    v_pk_fma_f32 v[156:157], v[156:157], v[220:221], v[156:157]
    v_pk_fma_f32 v[158:159], v[158:159], v[222:223], v[158:159]
    v_pk_fma_f32 v[144:145], v[112:113], v[176:177], v[144:145]
    v_pk_fma_f32 v[146:147], v[114:115], v[178:179], v[146:147]
    v_pk_fma_f32 v[148:149], v[116:117], v[180:181], v[148:149]
    v_pk_fma_f32 v[150:151], v[118:119], v[182:183], v[150:151]
    v_pk_fma_f32 v[152:153], v[120:121], v[184:185], v[152:153]
    v_pk_fma_f32 v[154:155], v[122:123], v[186:187], v[154:155]
    v_pk_fma_f32 v[156:157], v[124:125], v[188:189], v[156:157]
    v_pk_fma_f32 v[158:159], v[126:127], v[190:191], v[158:159]
    v_pk_fma_f32 v[176:177], v[176:177], v[208:209], v[176:177]
    v_pk_fma_f32 v[178:179], v[178:179], v[210:211], v[178:179]
    v_pk_fma_f32 v[180:181], v[180:181], v[212:213], v[180:181]
    v_pk_fma_f32 v[182:183], v[182:183], v[214:215], v[182:183]
    v_pk_fma_f32 v[184:185], v[184:185], v[216:217], v[184:185]
    v_pk_fma_f32 v[186:187], v[186:187], v[218:219], v[186:187]
    v_pk_fma_f32 v[188:189], v[188:189], v[220:221], v[188:189]
    v_pk_fma_f32 v[190:191], v[190:191], v[222:223], v[190:191]
    s_cbranch_scc1 L2_last
    s_mov_b64 exec, -1
    s_cmp_lg_u32 s21, s83
    s_cbranch_scc1 L2_np0
    s_setprio 0
L2_np0:
    s_add_u32 s40, s21, 2
    s_cmp_lt_u32 s40, s20
    s_cselect_b32 s6, 25088, 0
    s_mov_b32 m0, s37
    s_waitcnt lgkmcnt(0)
    v_mfma_f32_32x32x8_bf16 v[112:127], v[42:43], v[24:25], v[80:95]
    v_exp_f32 v208, v128
    v_exp_f32 v209, v129
    v_exp_f32 v210, v130
    v_exp_f32 v211, v131
    v_smfmac_f32_32x32x32_bf16 v[112:127], v[48:51], v[240:247], v52
    v_exp_f32 v212, v132
    v_exp_f32 v213, v133
    v_exp_f32 v214, v134
    v_exp_f32 v215, v135
    v_exp_f32 v216, v136
    v_exp_f32 v217, v137
    v_exp_f32 v218, v138
    v_exp_f32 v219, v139
    v_exp_f32 v220, v140
    v_exp_f32 v221, v141
    v_exp_f32 v222, v142
    v_exp_f32 v223, v143
    v_cmp_lt_u32_e64 s[26:27], s21, v13
    v_add_u32 v8, 8, v8
    v_add_u32 v9, 8, v9
    v_add_u32 v10, 8, v10
    v_add_u32 v11, 8, v11
    v_add_u32 v12, 8, v12
    buffer_load_dwordx4 v[16:17], s[4:7], 0 idxen offen offset:0 sc1 lds
    buffer_load_dwordx4 v[18:19], s[4:7], 0 idxen offen offset:1024 sc1 lds
    buffer_load_dwordx4 v[20:21], s[4:7], 0 idxen offen offset:2048 sc1 lds
    buffer_load_dwordx4 v[22:23], s[4:7], 0 idxen offen offset:3072 sc1 lds
    s_mov_b64 exec, s[24:25]
    v_pk_fma_f32 v[160:161], v[160:161], v[208:209], v[160:161]
    v_pk_fma_f32 v[162:163], v[162:163], v[210:211], v[162:163]
    v_pk_fma_f32 v[164:165], v[164:165], v[212:213], v[164:165]
    v_pk_fma_f32 v[166:167], v[166:167], v[214:215], v[166:167]
    v_pk_fma_f32 v[168:169], v[168:169], v[216:217], v[168:169]
    v_pk_fma_f32 v[170:171], v[170:171], v[218:219], v[170:171]
    v_pk_fma_f32 v[172:173], v[172:173], v[220:221], v[172:173]
    v_pk_fma_f32 v[174:175], v[174:175], v[222:223], v[174:175]
    v_pk_fma_f32 v[160:161], v[128:129], v[192:193], v[160:161]
    v_pk_fma_f32 v[162:163], v[130:131], v[194:195], v[162:163]
    v_pk_fma_f32 v[164:165], v[132:133], v[196:197], v[164:165]
    v_pk_fma_f32 v[166:167], v[134:135], v[198:199], v[166:167]
    v_pk_fma_f32 v[168:169], v[136:137], v[200:201], v[168:169]
    v_pk_fma_f32 v[170:171], v[138:139], v[202:203], v[170:171]
    v_pk_fma_f32 v[172:173], v[140:141], v[204:205], v[172:173]
    v_pk_fma_f32 v[174:175], v[142:143], v[206:207], v[174:175]
    v_pk_fma_f32 v[192:193], v[192:193], v[208:209], v[192:193]
    v_pk_fma_f32 v[194:195], v[194:195], v[210:211], v[194:195]
    v_pk_fma_f32 v[196:197], v[196:197], v[212:213], v[196:197]
    v_pk_fma_f32 v[198:199], v[198:199], v[214:215], v[198:199]
    v_pk_fma_f32 v[200:201], v[200:201], v[216:217], v[200:201]
    v_pk_fma_f32 v[202:203], v[202:203], v[218:219], v[202:203]
    v_pk_fma_f32 v[204:205], v[204:205], v[220:221], v[204:205]
    v_pk_fma_f32 v[206:207], v[206:207], v[222:223], v[206:207]
    s_mov_b64 exec, -1
    s_branch L2_loop
L2_last:
    s_mov_b64 s[42:43], exec
    s_mov_b64 exec, -1
    s_waitcnt lgkmcnt(0)
    ds_read_b128 v[80:83], v27 offset:0
    ds_read_b128 v[84:87], v27 offset:16
    ds_read_b128 v[88:91], v27 offset:64
    ds_read_b128 v[92:95], v27 offset:80
    ds_read_b128 v[96:99], v27 offset:128
    ds_read_b128 v[100:103], v27 offset:144
    ds_read_b128 v[104:107], v27 offset:192
    ds_read_b128 v[108:111], v27 offset:208
    v_exp_f32 v208, v128
    v_exp_f32 v209, v129
    v_exp_f32 v210, v130
    v_exp_f32 v211, v131
    v_exp_f32 v212, v132
    v_exp_f32 v213, v133
    v_exp_f32 v214, v134
    v_exp_f32 v215, v135
    v_exp_f32 v216, v136
    v_exp_f32 v217, v137
    v_exp_f32 v218, v138
    v_exp_f32 v219, v139
    v_exp_f32 v220, v140
    v_exp_f32 v221, v141
    v_exp_f32 v222, v142
    v_exp_f32 v223, v143
    ds_read_b64_tr_b16 v[56:57], v72 offset:0
    ds_read_b64_tr_b16 v[58:59], v72 offset:512
    ds_read_b64_tr_b16 v[240:241], v73 offset:0
    ds_read_b64_tr_b16 v[242:243], v73 offset:512
    ds_read_b64_tr_b16 v[60:61], v72 offset:2048
    ds_read_b64_tr_b16 v[62:63], v72 offset:2560
    ds_read_b64_tr_b16 v[244:245], v73 offset:2048
    s_mov_b64 exec, s[42:43]
    v_pk_fma_f32 v[160:161], v[160:161], v[208:209], v[160:161]
    v_pk_fma_f32 v[162:163], v[162:163], v[210:211], v[162:163]
    v_pk_fma_f32 v[164:165], v[164:165], v[212:213], v[164:165]
    v_pk_fma_f32 v[166:167], v[166:167], v[214:215], v[166:167]
    v_pk_fma_f32 v[168:169], v[168:169], v[216:217], v[168:169]
    v_pk_fma_f32 v[170:171], v[170:171], v[218:219], v[170:171]
    v_pk_fma_f32 v[172:173], v[172:173], v[220:221], v[172:173]
    v_pk_fma_f32 v[174:175], v[174:175], v[222:223], v[174:175]
    s_branch L_over7
L_pad7:
    s_branch L_back7
L_over7:
    v_pk_fma_f32 v[160:161], v[128:129], v[192:193], v[160:161]
    v_pk_fma_f32 v[162:163], v[130:131], v[194:195], v[162:163]
    v_pk_fma_f32 v[164:165], v[132:133], v[196:197], v[164:165]
    v_pk_fma_f32 v[166:167], v[134:135], v[198:199], v[166:167]
    v_pk_fma_f32 v[168:169], v[136:137], v[200:201], v[168:169]
    v_pk_fma_f32 v[170:171], v[138:139], v[202:203], v[170:171]
    v_pk_fma_f32 v[172:173], v[140:141], v[204:205], v[172:173]
    v_pk_fma_f32 v[174:175], v[142:143], v[206:207], v[174:175]
    v_pk_fma_f32 v[192:193], v[192:193], v[208:209], v[192:193]
    v_pk_fma_f32 v[194:195], v[194:195], v[210:211], v[194:195]
    v_pk_fma_f32 v[196:197], v[196:197], v[212:213], v[196:197]
    v_pk_fma_f32 v[198:199], v[198:199], v[214:215], v[198:199]
    v_pk_fma_f32 v[200:201], v[200:201], v[216:217], v[200:201]
    v_pk_fma_f32 v[202:203], v[202:203], v[218:219], v[202:203]
    v_pk_fma_f32 v[204:205], v[204:205], v[220:221], v[204:205]
    v_pk_fma_f32 v[206:207], v[206:207], v[222:223], v[206:207]
    s_mov_b64 exec, -1
    ds_read_b64_tr_b16 v[246:247], v73 offset:2560
    ds_read_b64_tr_b16 v[64:65], v72 offset:4096
    ds_read_b64_tr_b16 v[66:67], v72 offset:4608
    ds_read_b64_tr_b16 v[248:249], v73 offset:4096
    ds_read_b64_tr_b16 v[250:251], v73 offset:4608
    ds_read_b64_tr_b16 v[68:69], v72 offset:6144
    ds_read_b64_tr_b16 v[70:71], v72 offset:6656
    ds_read_b64_tr_b16 v[252:253], v73 offset:6144
    ds_read_b64_tr_b16 v[254:255], v73 offset:6656
L2_final:
    s_not_b64 exec, s[28:29]
    s_cbranch_execz L2_nz
    v_mov_b32 v224, 0
    v_mov_b32 v225, 0
    v_mov_b32 v226, 0
    v_mov_b32 v227, 0
    v_mov_b32 v228, 0
    v_mov_b32 v229, 0
    v_mov_b32 v230, 0
    v_mov_b32 v231, 0
    v_mov_b32 v232, 0
    v_mov_b32 v233, 0
    v_mov_b32 v234, 0
    v_mov_b32 v235, 0
    v_mov_b32 v236, 0
    v_mov_b32 v237, 0
    v_mov_b32 v238, 0
    v_mov_b32 v239, 0
L2_nz:
    s_mov_b64 exec, s[28:29]
    v_rcp_f32 v112, v176
    v_rcp_f32 v113, v177
    v_rcp_f32 v114, v178
    v_rcp_f32 v115, v179
    v_rcp_f32 v116, v180
    v_rcp_f32 v117, v181
    v_rcp_f32 v118, v182
    v_rcp_f32 v119, v183
    v_rcp_f32 v120, v184
    v_rcp_f32 v121, v185
    v_rcp_f32 v122, v186
    v_rcp_f32 v123, v187
    v_rcp_f32 v124, v188
    v_rcp_f32 v125, v189
    v_rcp_f32 v126, v190
    v_rcp_f32 v127, v191
    v_pk_fma_f32 v[14:15], v[176:177], v[178:179], v[14:15]
    v_pk_mul_f32 v[112:113], v[112:113], v[144:145]
    v_pk_mul_f32 v[114:115], v[114:115], v[146:147]
    v_pk_fma_f32 v[14:15], v[180:181], v[182:183], v[14:15]
    v_pk_mul_f32 v[116:117], v[116:117], v[148:149]
    v_pk_mul_f32 v[118:119], v[118:119], v[150:151]
    v_pk_fma_f32 v[14:15], v[184:185], v[186:187], v[14:15]
    v_pk_mul_f32 v[120:121], v[120:121], v[152:153]
    v_pk_mul_f32 v[122:123], v[122:123], v[154:155]
    v_pk_fma_f32 v[14:15], v[188:189], v[190:191], v[14:15]
    v_pk_mul_f32 v[124:125], v[124:125], v[156:157]
    v_pk_mul_f32 v[126:127], v[126:127], v[158:159]
    v_cvt_pk_bf16_f32 v224, v112, v113
    v_cvt_pk_bf16_f32 v225, v114, v115
    v_cvt_pk_bf16_f32 v226, v116, v117
    v_cvt_pk_bf16_f32 v227, v118, v119
    v_cvt_pk_bf16_f32 v228, v120, v121
    v_cvt_pk_bf16_f32 v229, v122, v123
    v_cvt_pk_bf16_f32 v230, v124, v125
    v_cvt_pk_bf16_f32 v231, v126, v127
    s_waitcnt vmcnt(0) lgkmcnt(0)
    v_rcp_f32 v128, v192
    v_mfma_f32_32x32x16_bf16 v[80:95], v[56:59], v[224:227], v[80:95]
    v_rcp_f32 v129, v193
    v_rcp_f32 v130, v194
    v_rcp_f32 v131, v195
    v_mfma_f32_32x32x16_bf16 v[96:111], v[240:243], v[224:227], v[96:111]
    v_rcp_f32 v132, v196
    v_rcp_f32 v133, v197
    v_rcp_f32 v134, v198
    v_mfma_f32_32x32x16_bf16 v[80:95], v[60:63], v[228:231], v[80:95]
    v_rcp_f32 v135, v199
    v_rcp_f32 v136, v200
    v_rcp_f32 v137, v201
    v_mfma_f32_32x32x16_bf16 v[96:111], v[244:247], v[228:231], v[96:111]
    v_rcp_f32 v138, v202
    v_rcp_f32 v139, v203
    v_rcp_f32 v140, v204
    v_rcp_f32 v141, v205
    v_rcp_f32 v142, v206
    v_rcp_f32 v143, v207
    v_pk_fma_f32 v[14:15], v[192:193], v[194:195], v[14:15]
    v_pk_mul_f32 v[128:129], v[128:129], v[160:161]
    v_pk_mul_f32 v[130:131], v[130:131], v[162:163]
    v_pk_fma_f32 v[14:15], v[196:197], v[198:199], v[14:15]
    v_pk_mul_f32 v[132:133], v[132:133], v[164:165]
    v_pk_mul_f32 v[134:135], v[134:135], v[166:167]
    v_pk_fma_f32 v[14:15], v[200:201], v[202:203], v[14:15]
    v_pk_mul_f32 v[136:137], v[136:137], v[168:169]
    v_pk_mul_f32 v[138:139], v[138:139], v[170:171]
    v_pk_fma_f32 v[14:15], v[204:205], v[206:207], v[14:15]
    v_pk_mul_f32 v[140:141], v[140:141], v[172:173]
    v_pk_mul_f32 v[142:143], v[142:143], v[174:175]
    v_cvt_pk_bf16_f32 v232, v128, v129
    v_cvt_pk_bf16_f32 v233, v130, v131
    v_cvt_pk_bf16_f32 v234, v132, v133
    v_cvt_pk_bf16_f32 v235, v134, v135
    v_cvt_pk_bf16_f32 v236, v136, v137
    v_cvt_pk_bf16_f32 v237, v138, v139
    v_cvt_pk_bf16_f32 v238, v140, v141
    v_cvt_pk_bf16_f32 v239, v142, v143
    s_nop 1
    v_mfma_f32_32x32x16_bf16 v[80:95], v[64:67], v[232:235], v[80:95]
    v_mfma_f32_32x32x16_bf16 v[96:111], v[248:251], v[232:235], v[96:111]
    v_mfma_f32_32x32x16_bf16 v[80:95], v[68:71], v[236:239], v[80:95]
    v_mfma_f32_32x32x16_bf16 v[96:111], v[252:255], v[236:239], v[96:111]
    v_mov_b32 v2, 0x7b800000
    v_add_f32 v3, v14, v15
    s_movk_i32 s40, 0x207
    v_cmp_nlt_f32 vcc, v3, v2
    s_mov_b64 exec, -1
    s_mov_b32 s3, 272
    v_and_b32 v2, 3, v1
    v_and_b32 v3, 0xff, v29
    v_lshl_add_u32 v34, v2, 5, s19
    v_mad_u32_u24 v34, v3, s3, v34
    v_lshrrev_b32 v3, 25, v29
    v_lshl_add_u32 v36, v3, 8, s16
    v_lshlrev_b32 v36, 7, v36
    v_lshl_add_u32 v36, v2, 4, v36
    v_bfe_u32 v37, v29, 22, 3
    v_cmp_class_f32_e64 s[42:43], v96, s40
    s_lshl_b32 s41, s18, 2
    s_and_b64 s[42:43], s[42:43], s[28:29]
    s_or_b64 vcc, vcc, s[42:43]
    s_cselect_b32 s42, 1, 0
    s_andn2_b32 s42, s42, s31
    s_cbranch_scc1 L2_safe
    ds_write_b128 v26, v[80:83] offset:0
    ds_write_b128 v26, v[84:87] offset:16
    ds_write_b128 v26, v[88:91] offset:64
    ds_write_b128 v26, v[92:95] offset:80
    ds_write_b128 v26, v[96:99] offset:128
    ds_write_b128 v26, v[100:103] offset:144
    ds_write_b128 v26, v[104:107] offset:192
    ds_write_b128 v26, v[108:111] offset:208
    v_mov_b32 v2, s41
    v_mov_b32 v3, 1
    v_cmp_lt_u32_e64 s[44:45], 2, v37
    v_cmp_lt_u32_e64 s[46:47], 3, v37
    s_waitcnt lgkmcnt(0)
    ds_write_b32 v2, v3 offset:544
    s_cmp_eq_u32 s34, 0
    s_cbranch_scc1 L2_nowait
L2_poll:
    ds_read_b32 v3, v2 offset:548
    s_waitcnt lgkmcnt(0)
    v_cmp_eq_u32 vcc, 0, v3
    s_cbranch_vccnz L2_poll
L2_nowait:
    ds_read_b128 v[144:147], v34 offset:0
    ds_read_b128 v[148:151], v34 offset:16
    ds_read_b128 v[152:155], v34 offset:128
    ds_read_b128 v[156:159], v34 offset:144
    ds_read_b128 v[160:163], v34 offset:272
    ds_read_b128 v[164:167], v34 offset:288
    ds_read_b128 v[168:171], v34 offset:400
    ds_read_b128 v[172:175], v34 offset:416
    ds_read_b128 v[176:179], v34 offset:544
    ds_read_b128 v[180:183], v34 offset:560
    ds_read_b128 v[184:187], v34 offset:672
    ds_read_b128 v[188:191], v34 offset:688
    s_cmp_eq_u64 s[46:47], 0
    s_cbranch_scc1 L2_no4
    ds_read_b128 v[192:195], v34 offset:816
    ds_read_b128 v[196:199], v34 offset:832
    ds_read_b128 v[200:203], v34 offset:944
    ds_read_b128 v[204:207], v34 offset:960
    s_waitcnt lgkmcnt(0)
    s_mov_b64 exec, s[46:47]
    v_pk_add_f32 v[144:145], v[144:145], v[192:193]
    v_pk_add_f32 v[146:147], v[146:147], v[194:195]
    v_pk_add_f32 v[148:149], v[148:149], v[196:197]
    v_pk_add_f32 v[150:151], v[150:151], v[198:199]
    v_pk_add_f32 v[152:153], v[152:153], v[200:201]
    v_pk_add_f32 v[154:155], v[154:155], v[202:203]
    v_pk_add_f32 v[156:157], v[156:157], v[204:205]
    v_pk_add_f32 v[158:159], v[158:159], v[206:207]
    s_mov_b64 exec, -1
L2_no4:
    s_waitcnt lgkmcnt(4)
    v_pk_add_f32 v[144:145], v[144:145], v[160:161]
    v_pk_add_f32 v[146:147], v[146:147], v[162:163]
    v_pk_add_f32 v[148:149], v[148:149], v[164:165]
    v_pk_add_f32 v[150:151], v[150:151], v[166:167]
    v_pk_add_f32 v[152:153], v[152:153], v[168:169]
    v_pk_add_f32 v[154:155], v[154:155], v[170:171]
    v_pk_add_f32 v[156:157], v[156:157], v[172:173]
    v_pk_add_f32 v[158:159], v[158:159], v[174:175]
    s_waitcnt lgkmcnt(0)
    s_mov_b64 exec, s[44:45]
    v_pk_add_f32 v[144:145], v[144:145], v[176:177]
    v_pk_add_f32 v[146:147], v[146:147], v[178:179]
    v_pk_add_f32 v[148:149], v[148:149], v[180:181]
    v_pk_add_f32 v[150:151], v[150:151], v[182:183]
    v_pk_add_f32 v[152:153], v[152:153], v[184:185]
    v_pk_add_f32 v[154:155], v[154:155], v[186:187]
    v_pk_add_f32 v[156:157], v[156:157], v[188:189]
    v_pk_add_f32 v[158:159], v[158:159], v[190:191]
    s_mov_b64 exec, -1
    s_cmp_eq_u32 s30, 1
    s_cbranch_scc1 L2_writeback
    v_exp_f32 v208, v144
    v_exp_f32 v209, v145
    v_exp_f32 v210, v146
    v_exp_f32 v211, v147
    v_exp_f32 v212, v148
    v_exp_f32 v213, v149
    v_exp_f32 v214, v150
    v_exp_f32 v215, v151
    v_exp_f32 v216, v152
    v_exp_f32 v217, v153
    v_exp_f32 v218, v154
    v_exp_f32 v219, v155
    v_exp_f32 v220, v156
    v_exp_f32 v221, v157
    v_exp_f32 v222, v158
    v_exp_f32 v223, v159
    v_pk_fma_f32 v[208:209], v[208:209], s[58:59], s[58:59]
    v_pk_fma_f32 v[210:211], v[210:211], s[58:59], s[58:59]
    v_pk_fma_f32 v[212:213], v[212:213], s[58:59], s[58:59]
    v_pk_fma_f32 v[214:215], v[214:215], s[58:59], s[58:59]
    v_pk_fma_f32 v[216:217], v[216:217], s[58:59], s[58:59]
    v_pk_fma_f32 v[218:219], v[218:219], s[58:59], s[58:59]
    v_pk_fma_f32 v[220:221], v[220:221], s[58:59], s[58:59]
    v_pk_fma_f32 v[222:223], v[222:223], s[58:59], s[58:59]
    v_rcp_f32 v208, v208
    v_rcp_f32 v209, v209
    v_rcp_f32 v210, v210
    v_rcp_f32 v211, v211
    v_rcp_f32 v212, v212
    v_rcp_f32 v213, v213
    v_rcp_f32 v214, v214
    v_rcp_f32 v215, v215
    v_rcp_f32 v216, v216
    v_rcp_f32 v217, v217
    v_rcp_f32 v218, v218
    v_rcp_f32 v219, v219
    v_rcp_f32 v220, v220
    v_rcp_f32 v221, v221
    v_rcp_f32 v222, v222
    v_rcp_f32 v223, v223
    v_pk_mul_f32 v[208:209], v[208:209], v[144:145]
    v_pk_mul_f32 v[210:211], v[210:211], v[146:147]
    v_pk_mul_f32 v[212:213], v[212:213], v[148:149]
    v_pk_mul_f32 v[214:215], v[214:215], v[150:151]
    v_pk_mul_f32 v[216:217], v[216:217], v[152:153]
    v_pk_mul_f32 v[218:219], v[218:219], v[154:155]
    v_pk_mul_f32 v[220:221], v[220:221], v[156:157]
    v_pk_mul_f32 v[222:223], v[222:223], v[158:159]
    v_cvt_pk_bf16_f32 v240, v208, v209
    v_cvt_pk_bf16_f32 v241, v210, v211
    v_cvt_pk_bf16_f32 v242, v212, v213
    v_cvt_pk_bf16_f32 v243, v214, v215
    buffer_store_dwordx4 v[240:243], v36, s[12:15], 0 offen sc1
    v_cvt_pk_bf16_f32 v244, v216, v217
    v_cvt_pk_bf16_f32 v245, v218, v219
    v_cvt_pk_bf16_f32 v246, v220, v221
    v_cvt_pk_bf16_f32 v247, v222, v223
    buffer_store_dwordx4 v[244:247], v36, s[12:15], 0 offen offset:64 sc1
L_end:
    s_endpgm
L2_extra:
    s_mov_b32 s36, 1
    v_cmp_le_u32 vcc, 0x88800000, v3
    s_cbranch_vccz L2_noflag
    s_mov_b32 s36, 3
L2_noflag:
    v_add_u32 v3, 0xfc000080, v180
    v_and_b32 v3, s50, v3
    buffer_load_dwordx4 v[160:163], v3, s[8:11], 0 offen sc1
    v_add_u32 v3, 0xfc000080, v181
    v_and_b32 v3, s50, v3
    buffer_load_dwordx4 v[164:167], v3, s[8:11], 0 offen sc1
    v_add_u32 v3, 0xfc000080, v182
    v_and_b32 v3, s50, v3
    buffer_load_dwordx4 v[168:171], v3, s[8:11], 0 offen sc1
    v_add_u32 v3, 0xfc000080, v183
    v_and_b32 v3, s50, v3
    buffer_load_dwordx4 v[172:175], v3, s[8:11], 0 offen sc1
    s_branch L2_noextra
L2_xpl:
    s_waitcnt vmcnt(5)
    v_lshlrev_b32_sdwa v124, 2, v163 dst_sel:DWORD dst_unused:UNUSED_PAD src0_sel:DWORD src1_sel:BYTE_0
    v_lshlrev_b32_sdwa v125, 2, v163 dst_sel:DWORD dst_unused:UNUSED_PAD src0_sel:DWORD src1_sel:BYTE_1
    v_lshlrev_b32_sdwa v126, 2, v163 dst_sel:DWORD dst_unused:UNUSED_PAD src0_sel:DWORD src1_sel:BYTE_2
    v_cmpx_ne_u32 vcc, 0, v124
    ds_add_rtn_u32 v112, v124, v2 offset:0
    v_cmpx_ne_u32 vcc, 0, v125
    ds_add_rtn_u32 v113, v125, v2 offset:0
    v_cmpx_ne_u32 vcc, 0, v126
    ds_add_rtn_u32 v114, v126, v2 offset:0
    s_mov_b64 exec, -1
    v_lshlrev_b32_sdwa v127, 2, v167 dst_sel:DWORD dst_unused:UNUSED_PAD src0_sel:DWORD src1_sel:BYTE_0
    v_lshlrev_b32_sdwa v128, 2, v167 dst_sel:DWORD dst_unused:UNUSED_PAD src0_sel:DWORD src1_sel:BYTE_1
    v_lshlrev_b32_sdwa v129, 2, v167 dst_sel:DWORD dst_unused:UNUSED_PAD src0_sel:DWORD src1_sel:BYTE_2
    v_cmpx_ne_u32 vcc, 0, v127
    ds_add_rtn_u32 v115, v127, v2 offset:0
    v_cmpx_ne_u32 vcc, 0, v128
    ds_add_rtn_u32 v116, v128, v2 offset:0
    v_cmpx_ne_u32 vcc, 0, v129
    ds_add_rtn_u32 v117, v129, v2 offset:0
    s_mov_b64 exec, -1
    v_lshlrev_b32_sdwa v130, 2, v171 dst_sel:DWORD dst_unused:UNUSED_PAD src0_sel:DWORD src1_sel:BYTE_0
    v_lshlrev_b32_sdwa v131, 2, v171 dst_sel:DWORD dst_unused:UNUSED_PAD src0_sel:DWORD src1_sel:BYTE_1
    v_lshlrev_b32_sdwa v132, 2, v171 dst_sel:DWORD dst_unused:UNUSED_PAD src0_sel:DWORD src1_sel:BYTE_2
    v_cmpx_ne_u32 vcc, 0, v130
    ds_add_rtn_u32 v118, v130, v2 offset:0
    v_cmpx_ne_u32 vcc, 0, v131
    ds_add_rtn_u32 v119, v131, v2 offset:0
    v_cmpx_ne_u32 vcc, 0, v132
    ds_add_rtn_u32 v120, v132, v2 offset:0
    s_mov_b64 exec, -1
    v_lshlrev_b32_sdwa v133, 2, v175 dst_sel:DWORD dst_unused:UNUSED_PAD src0_sel:DWORD src1_sel:BYTE_0
    v_lshlrev_b32_sdwa v134, 2, v175 dst_sel:DWORD dst_unused:UNUSED_PAD src0_sel:DWORD src1_sel:BYTE_1
    v_lshlrev_b32_sdwa v135, 2, v175 dst_sel:DWORD dst_unused:UNUSED_PAD src0_sel:DWORD src1_sel:BYTE_2
    v_cmpx_ne_u32 vcc, 0, v133
    ds_add_rtn_u32 v121, v133, v2 offset:0
    v_cmpx_ne_u32 vcc, 0, v134
    ds_add_rtn_u32 v122, v134, v2 offset:0
    v_cmpx_ne_u32 vcc, 0, v135
    ds_add_rtn_u32 v123, v135, v2 offset:0
    s_mov_b64 exec, -1
    v_mov_b32 v3, s36
    v_mov_b32 v208, 584
    ds_or_b32 v208, v3
    s_waitcnt lgkmcnt(0)
    v_cmpx_gt_u32 vcc, s51, v112
    ds_write_b32 v112, v160
    v_cmpx_gt_u32 vcc, s51, v113
    ds_write_b32 v113, v161
    v_cmpx_gt_u32 vcc, s51, v114
    ds_write_b32 v114, v162
    s_mov_b64 exec, -1
    v_cmpx_gt_u32 vcc, s51, v115
    ds_write_b32 v115, v164
    v_cmpx_gt_u32 vcc, s51, v116
    ds_write_b32 v116, v165
    v_cmpx_gt_u32 vcc, s51, v117
    ds_write_b32 v117, v166
    s_mov_b64 exec, -1
    v_cmpx_gt_u32 vcc, s51, v118
    ds_write_b32 v118, v168
    v_cmpx_gt_u32 vcc, s51, v119
    ds_write_b32 v119, v169
    v_cmpx_gt_u32 vcc, s51, v120
    ds_write_b32 v120, v170
    s_mov_b64 exec, -1
    v_cmpx_gt_u32 vcc, s51, v121
    ds_write_b32 v121, v172
    v_cmpx_gt_u32 vcc, s51, v122
    ds_write_b32 v122, v173
    v_cmpx_gt_u32 vcc, s51, v123
    ds_write_b32 v123, v174
    s_mov_b64 exec, -1
    s_branch L2_pl
L_timeout:
    v_mov_b32 v3, 6
    v_mov_b32 v2, 584
    ds_or_b32 v2, v3
    s_branch L2_build
L2_retry2:
    s_barrier
    s_cmp_eq_u32 s35, 2
    s_cselect_b32 s3, 36, 64
    s_add_u32 s48, s3, 1
    s_lshr_b32 s48, s48, 1
    s_mul_i32 s49, s48, 3
    v_subrev_u32 v112, 1, v1
    v_max_i32 v112, 0, v112
    v_cmp_lt_u32 vcc, s3, v112
    v_cmp_lt_u32_e64 s[50:51], s49, v112
    v_mov_b32 v113, 2
    v_mov_b32 v114, 32768
    v_mov_b32 v115, 21846
    v_cndmask_b32_e64 v113, v113, 3, vcc
    v_cndmask_b32 v114, v114, v115, vcc
    v_mov_b32 v115, 16384
    v_cndmask_b32_e64 v113, v113, 4, s[50:51]
    v_cndmask_b32_e64 v114, v114, v115, s[50:51]
    v_add3_u32 v115, v112, v113, -1
    v_mul_u32_u24 v115, v115, v114
    v_lshrrev_b32 v115, 16, v115
    v_mov_b32 v116, 0
    v_min_u32 v117, v116, v112
    v_sub_u32 v118, v112, v117
    v_min_u32 v118, v118, v115
    v_add3_u32 v117, v117, v113, -1
    v_max_i32 v117, 0, v117
    v_lshl_or_b32 v117, v117, 25, 0
    v_lshl_or_b32 v124, v118, 16, v117
    v_add_u32 v116, v116, v115
    v_min_u32 v117, v116, v112
    v_sub_u32 v118, v112, v117
    v_min_u32 v118, v118, v115
    v_add3_u32 v117, v117, v113, -3
    v_max_i32 v117, 0, v117
    v_lshl_or_b32 v117, v117, 25, 4
    v_lshl_or_b32 v125, v118, 16, v117
    v_add_u32 v116, v116, v115
    v_min_u32 v117, v116, v112
    v_sub_u32 v118, v112, v117
    v_min_u32 v118, v118, v115
    v_add3_u32 v117, v117, v113, -5
    v_max_i32 v117, 0, v117
    v_lshl_or_b32 v117, v117, 25, 8
    v_lshl_or_b32 v126, v118, 16, v117
    v_add_u32 v116, v116, v115
    v_min_u32 v117, v116, v112
    v_sub_u32 v118, v112, v117
    v_min_u32 v118, v118, v115
    v_add3_u32 v117, v117, v113, -7
    v_max_i32 v117, 0, v117
    v_lshl_or_b32 v117, v117, 25, 12
    v_lshl_or_b32 v127, v118, 16, v117
    v_add_u32 v116, v116, v115
    v_lshl_or_b32 v124, v113, 22, v124
    v_sub_u32 v116, s48, v115
    v_min_u32 v116, 5, v116
    v_mul_u32_u24 v130, 10, v116
    v_cmp_le_u32 vcc, 3, v116
    v_add_u32 v117, 2, v130
    v_mov_b32 v120, v113
    v_mov_b32 v121, 0
    v_cndmask_b32 v130, v130, v117, vcc
    v_cmp_ne_u32 vcc, 0, v1
    v_lshlrev_b64 v[128:129], v130, v[120:121]
    v_mov_b32 v131, 0
    v_cndmask_b32 v128, v121, v128, vcc
    v_cndmask_b32 v129, v121, v129, vcc
    v_lshlrev_b32 v117, 5, v1
    ds_write_b128 v117, v[124:127] offset:4096
    ds_write_b128 v117, v[128:131] offset:4112
    s_branch L2_retry1
L2_safe:
    s_mov_b32 s31, 1
    s_mov_b32 s6, 25088
    s_nop 7
    ds_read_b128 v[80:83], v28 offset:0
    ds_read_b128 v[84:87], v28 offset:16
    ds_read_b128 v[88:91], v28 offset:64
    ds_read_b128 v[92:95], v28 offset:80
    ds_read_b128 v[96:99], v28 offset:128
    ds_read_b128 v[100:103], v28 offset:144
    ds_read_b128 v[104:107], v28 offset:192
    ds_read_b128 v[108:111], v28 offset:208
    v_and_b32 v2, 0xffff, v31
    v_sub_u32 v2, v12, v2
    v_sub_u32 v8, v8, v2
    v_sub_u32 v9, v9, v2
    v_sub_u32 v10, v10, v2
    v_sub_u32 v11, v11, v2
    v_sub_u32 v12, v12, v2
    v_mov_b32 v144, 0
    v_mov_b32 v176, 1.0
    v_mov_b32 v145, 0
    v_mov_b32 v177, 1.0
    v_mov_b32 v146, 0
    v_mov_b32 v178, 1.0
    v_mov_b32 v147, 0
    v_mov_b32 v179, 1.0
    v_mov_b32 v148, 0
    v_mov_b32 v180, 1.0
    v_mov_b32 v149, 0
    v_mov_b32 v181, 1.0
    v_mov_b32 v150, 0
    v_mov_b32 v182, 1.0
    v_mov_b32 v151, 0
    v_mov_b32 v183, 1.0
    v_mov_b32 v152, 0
    v_mov_b32 v184, 1.0
    v_mov_b32 v153, 0
    v_mov_b32 v185, 1.0
    v_mov_b32 v154, 0
    v_mov_b32 v186, 1.0
    v_mov_b32 v155, 0
    v_mov_b32 v187, 1.0
    v_mov_b32 v156, 0
    v_mov_b32 v188, 1.0
    v_mov_b32 v157, 0
    v_mov_b32 v189, 1.0
    v_mov_b32 v158, 0
    v_mov_b32 v190, 1.0
    v_mov_b32 v159, 0
    v_mov_b32 v191, 1.0
    v_mov_b32 v160, 0
    v_mov_b32 v192, 1.0
    v_mov_b32 v161, 0
    v_mov_b32 v193, 1.0
    v_mov_b32 v162, 0
    v_mov_b32 v194, 1.0
    v_mov_b32 v163, 0
    v_mov_b32 v195, 1.0
    v_mov_b32 v164, 0
    v_mov_b32 v196, 1.0
    v_mov_b32 v165, 0
    v_mov_b32 v197, 1.0
    v_mov_b32 v166, 0
    v_mov_b32 v198, 1.0
    v_mov_b32 v167, 0
    v_mov_b32 v199, 1.0
    v_mov_b32 v168, 0
    v_mov_b32 v200, 1.0
    v_mov_b32 v169, 0
    v_mov_b32 v201, 1.0
    v_mov_b32 v170, 0
    v_mov_b32 v202, 1.0
    v_mov_b32 v171, 0
    v_mov_b32 v203, 1.0
    v_mov_b32 v172, 0
    v_mov_b32 v204, 1.0
    v_mov_b32 v173, 0
    v_mov_b32 v205, 1.0
    v_mov_b32 v174, 0
    v_mov_b32 v206, 1.0
    v_mov_b32 v175, 0
    v_mov_b32 v207, 1.0
    v_mov_b32 v25, 0x7f00
    s_mov_b32 s21, 0
    ds_read_u16 v16, v76 offset:0
    ds_read_u16 v18, v77 offset:0
    ds_read_u16 v20, v78 offset:0
    ds_read_u16 v22, v79 offset:0
    ds_read_b32 v24, v53
    s_branch L2_safe_in
L2_safe_loop:
    ds_read_u16 v16, v8 offset:0
    ds_read_u16 v18, v9 offset:0
    ds_read_u16 v20, v10 offset:0
    ds_read_u16 v22, v11 offset:0
    ds_read_b32 v24, v12
L2_safe_in:
    s_waitcnt lgkmcnt(0)
    s_mov_b32 m0, s19
    s_nop 0
    buffer_load_dwordx4 v[16:17], s[4:7], 0 idxen offen offset:0 sc1 lds
    buffer_load_dwordx4 v[18:19], s[4:7], 0 idxen offen offset:1024 sc1 lds
    buffer_load_dwordx4 v[20:21], s[4:7], 0 idxen offen offset:2048 sc1 lds
    buffer_load_dwordx4 v[22:23], s[4:7], 0 idxen offen offset:3072 sc1 lds
    v_cmp_lt_u32_e64 s[24:25], s21, v13
    v_add_u32 v8, 4, v8
    v_add_u32 v9, 4, v9
    v_add_u32 v10, 4, v10
    v_add_u32 v11, 4, v11
    v_add_u32 v12, 4, v12
    s_waitcnt vmcnt(0)
    ds_read_b128 v[224:227], v4 offset:0
    ds_read_b128 v[228:231], v5 offset:0
    ds_read_b128 v[232:235], v6 offset:0
    ds_read_b128 v[236:239], v7 offset:0
    s_waitcnt lgkmcnt(0)
    v_mfma_f32_32x32x8_bf16 v[112:127], v[40:41], v[24:25], v[80:95]
    v_smfmac_f32_32x32x32_bf16 v[112:127], v[48:51], v[224:231], v52
    v_mfma_f32_32x32x8_bf16 v[128:143], v[44:45], v[24:25], v[96:111]
    v_smfmac_f32_32x32x32_bf16 v[128:143], v[48:51], v[232:239], v52
    s_nop 7
    s_nop 3
    s_mov_b64 exec, s[24:25]
    v_exp_f32 v208, v112
    v_exp_f32 v209, v113
    v_exp_f32 v210, v114
    v_exp_f32 v211, v115
    v_exp_f32 v212, v116
    v_exp_f32 v213, v117
    v_exp_f32 v214, v118
    v_exp_f32 v215, v119
    v_exp_f32 v216, v120
    v_exp_f32 v217, v121
    v_exp_f32 v218, v122
    v_exp_f32 v219, v123
    v_exp_f32 v220, v124
    v_exp_f32 v221, v125
    v_exp_f32 v222, v126
    v_exp_f32 v223, v127
    v_pk_add_f32 v[208:209], v[208:209], s[22:23]
    v_pk_add_f32 v[210:211], v[210:211], s[22:23]
    v_pk_add_f32 v[212:213], v[212:213], s[22:23]
    v_pk_add_f32 v[214:215], v[214:215], s[22:23]
    v_pk_add_f32 v[216:217], v[216:217], s[22:23]
    v_pk_add_f32 v[218:219], v[218:219], s[22:23]
    v_pk_add_f32 v[220:221], v[220:221], s[22:23]
    v_pk_add_f32 v[222:223], v[222:223], s[22:23]
    v_rcp_f32 v208, v208
    v_rcp_f32 v209, v209
    v_rcp_f32 v210, v210
    v_rcp_f32 v211, v211
    v_rcp_f32 v212, v212
    v_rcp_f32 v213, v213
    v_rcp_f32 v214, v214
    v_rcp_f32 v215, v215
    v_rcp_f32 v216, v216
    v_rcp_f32 v217, v217
    v_rcp_f32 v218, v218
    v_rcp_f32 v219, v219
    v_rcp_f32 v220, v220
    v_rcp_f32 v221, v221
    v_rcp_f32 v222, v222
    v_rcp_f32 v223, v223
    v_pk_fma_f32 v[144:145], v[112:113], v[208:209], v[144:145]
    v_pk_fma_f32 v[146:147], v[114:115], v[210:211], v[146:147]
    v_pk_fma_f32 v[148:149], v[116:117], v[212:213], v[148:149]
    v_pk_fma_f32 v[150:151], v[118:119], v[214:215], v[150:151]
    v_pk_fma_f32 v[152:153], v[120:121], v[216:217], v[152:153]
    v_pk_fma_f32 v[154:155], v[122:123], v[218:219], v[154:155]
    v_pk_fma_f32 v[156:157], v[124:125], v[220:221], v[156:157]
    v_pk_fma_f32 v[158:159], v[126:127], v[222:223], v[158:159]
    v_exp_f32 v208, v128
    v_exp_f32 v209, v129
    v_exp_f32 v210, v130
    v_exp_f32 v211, v131
    v_exp_f32 v212, v132
    v_exp_f32 v213, v133
    v_exp_f32 v214, v134
    v_exp_f32 v215, v135
    v_exp_f32 v216, v136
    v_exp_f32 v217, v137
    v_exp_f32 v218, v138
    v_exp_f32 v219, v139
    v_exp_f32 v220, v140
    v_exp_f32 v221, v141
    v_exp_f32 v222, v142
    v_exp_f32 v223, v143
    v_pk_add_f32 v[208:209], v[208:209], s[22:23]
    v_pk_add_f32 v[210:211], v[210:211], s[22:23]
    v_pk_add_f32 v[212:213], v[212:213], s[22:23]
    v_pk_add_f32 v[214:215], v[214:215], s[22:23]
    v_pk_add_f32 v[216:217], v[216:217], s[22:23]
    v_pk_add_f32 v[218:219], v[218:219], s[22:23]
    v_pk_add_f32 v[220:221], v[220:221], s[22:23]
    v_pk_add_f32 v[222:223], v[222:223], s[22:23]
    v_rcp_f32 v208, v208
    v_rcp_f32 v209, v209
    v_rcp_f32 v210, v210
    v_rcp_f32 v211, v211
    v_rcp_f32 v212, v212
    v_rcp_f32 v213, v213
    v_rcp_f32 v214, v214
    v_rcp_f32 v215, v215
    v_rcp_f32 v216, v216
    v_rcp_f32 v217, v217
    v_rcp_f32 v218, v218
    v_rcp_f32 v219, v219
    v_rcp_f32 v220, v220
    v_rcp_f32 v221, v221
    v_rcp_f32 v222, v222
    v_rcp_f32 v223, v223
    v_pk_fma_f32 v[160:161], v[128:129], v[208:209], v[160:161]
    v_pk_fma_f32 v[162:163], v[130:131], v[210:211], v[162:163]
    v_pk_fma_f32 v[164:165], v[132:133], v[212:213], v[164:165]
    v_pk_fma_f32 v[166:167], v[134:135], v[214:215], v[166:167]
    v_pk_fma_f32 v[168:169], v[136:137], v[216:217], v[168:169]
    v_pk_fma_f32 v[170:171], v[138:139], v[218:219], v[170:171]
    v_pk_fma_f32 v[172:173], v[140:141], v[220:221], v[172:173]
    v_pk_fma_f32 v[174:175], v[142:143], v[222:223], v[174:175]
    s_mov_b64 exec, -1
    s_add_u32 s21, s21, 1
    s_cmp_lt_u32 s21, s20
    s_cbranch_scc1 L2_safe_loop
    ds_read_b128 v[80:83], v27 offset:0
    ds_read_b128 v[84:87], v27 offset:16
    ds_read_b128 v[88:91], v27 offset:64
    ds_read_b128 v[92:95], v27 offset:80
    ds_read_b128 v[96:99], v27 offset:128
    ds_read_b128 v[100:103], v27 offset:144
    ds_read_b128 v[104:107], v27 offset:192
    ds_read_b128 v[108:111], v27 offset:208
    s_branch L2_final
L2_slow:
    s_mov_b32 s30, 1
    s_mov_b32 s38, 0
    v_mov_b32 v39, 0
    v_cmp_gt_u32 vcc, 4, v214
    s_waitcnt vmcnt(0) lgkmcnt(0)
    s_cbranch_vccnz L2_slow_round
    s_barrier
    v_and_b32 v2, 16, v1
    v_lshlrev_b32 v2, 2, v2
    v_xor_b32 v2, v2, v30
    s_lshl_b32 s3, s17, 10
    v_add_u32 v2, s3, v2
    s_add_u32 m0, s3, 77312
    v_lshrrev_b32 v3, 4, v1
    global_load_lds_dwordx4 v2, s[72:73]
    v_bfe_u32 v2, v1, 2, 2
    v_lshl_add_u32 v208, v3, 3, v2
    v_lshlrev_b32 v208, 7, v208
    v_lshrrev_b32 v2, 1, v2
    v_lshl_or_b32 v208, v2, 6, v208
    v_and_b32 v2, 3, v1
    v_lshl_or_b32 v208, v2, 4, v208
    v_xor_b32 v209, 64, v208
    v_add_u32 v208, 77312, v208
    v_add_u32 v209, 77312, v209
    v_and_b32 v2, 15, v1
    s_lshl_b32 s3, s17, 4
    v_add_u32 v210, s3, v2
    v_lshlrev_b32 v212, 4, v3
    v_add_u32 v215, 3072, v212
    s_mov_b32 s6, 25088
    s_waitcnt vmcnt(0)
    s_barrier
    ds_read_b64_tr_b16 v[80:81], v208 offset:0
    ds_read_b64_tr_b16 v[82:83], v208 offset:512
    ds_read_b64_tr_b16 v[84:85], v208 offset:4096
    ds_read_b64_tr_b16 v[86:87], v208 offset:4608
    ds_read_b64_tr_b16 v[88:89], v208 offset:8
    ds_read_b64_tr_b16 v[90:91], v208 offset:520
    ds_read_b64_tr_b16 v[92:93], v208 offset:4104
    ds_read_b64_tr_b16 v[94:95], v208 offset:4616
    s_waitcnt lgkmcnt(0)
    ds_read_b64_tr_b16 v[96:97], v209 offset:0
    ds_read_b64_tr_b16 v[98:99], v209 offset:512
    ds_read_b64_tr_b16 v[100:101], v209 offset:4096
    ds_read_b64_tr_b16 v[102:103], v209 offset:4608
    ds_read_b64_tr_b16 v[104:105], v209 offset:8
    ds_read_b64_tr_b16 v[106:107], v209 offset:520
    ds_read_b64_tr_b16 v[108:109], v209 offset:4104
    ds_read_b64_tr_b16 v[110:111], v209 offset:4616
    s_mov_b32 s3, 196
    s_mov_b32 s82, 0
L_allp:
    v_min_u32 v2, 24999, v210
    v_lshl_add_u32 v2, v2, 7, v212
    global_load_dwordx4 v[224:227], v2, s[64:65]
    global_load_dwordx4 v[228:231], v2, s[64:65] offset:64
    v_and_b32 v2, 255, v210
    v_lshrrev_b32 v214, 8, v210
    v_mul_u32_u24 v2, 98, v2
    v_add_u32 v214, v2, v214
    s_waitcnt vmcnt(0) lgkmcnt(0)
    v_mfma_f32_16x16x32_bf16 v[112:115], v[80:83], v[224:227], 0
    v_mfma_f32_16x16x32_bf16 v[116:119], v[88:91], v[224:227], 0
    v_mfma_f32_16x16x32_bf16 v[120:123], v[96:99], v[224:227], 0
    v_mfma_f32_16x16x32_bf16 v[124:127], v[104:107], v[224:227], 0
    v_mfma_f32_16x16x32_bf16 v[112:115], v[84:87], v[228:231], v[112:115]
    v_mfma_f32_16x16x32_bf16 v[116:119], v[92:95], v[228:231], v[116:119]
    v_mfma_f32_16x16x32_bf16 v[120:123], v[100:103], v[228:231], v[120:123]
    v_mfma_f32_16x16x32_bf16 v[124:127], v[108:111], v[228:231], v[124:127]
    s_nop 7
    v_pk_mul_f32 v[112:113], v[112:113], s[58:59]
    v_pk_mul_f32 v[114:115], v[114:115], s[58:59]
    v_pk_mul_f32 v[116:117], v[116:117], s[58:59]
    v_pk_mul_f32 v[118:119], v[118:119], s[58:59]
    v_pk_mul_f32 v[120:121], v[120:121], s[58:59]
    v_pk_mul_f32 v[122:123], v[122:123], s[58:59]
    v_pk_mul_f32 v[124:125], v[124:125], s[58:59]
    v_pk_mul_f32 v[126:127], v[126:127], s[58:59]
    v_cvt_pk_bf16_f32 v128, v112, v113
    v_cvt_pk_bf16_f32 v129, v114, v115
    v_cvt_pk_bf16_f32 v130, v116, v117
    v_cvt_pk_bf16_f32 v131, v118, v119
    v_cvt_pk_bf16_f32 v132, v120, v121
    v_cvt_pk_bf16_f32 v133, v122, v123
    v_cvt_pk_bf16_f32 v134, v124, v125
    v_cvt_pk_bf16_f32 v135, v126, v127
    buffer_store_dwordx4 v[128:131], v[214:215], s[4:7], 0 idxen offen sc1
    buffer_store_dwordx4 v[132:135], v[214:215], s[4:7], 0 idxen offen offset:64 sc1
    v_add_u32 v210, 128, v210
    s_sub_u32 s3, s3, 1
    s_cmp_lg_u32 s3, 0
    s_cbranch_scc1 L_allp
    s_waitcnt vmcnt(0)
    s_branch L2_slow_round
L2_writeback:
    v_cmp_ne_u32 vcc, 0, v37
    v_lshrrev_b32 v3, 25, v29
    v_and_b32 v2, 3, v1
    v_lshlrev_b32 v2, 5, v2
    v_mad_u32_u24 v2, v3, s3, v2
    v_add_u32 v2, 136832, v2
    s_mov_b64 exec, vcc
    ds_write_b128 v2, v[144:147] offset:0
    ds_write_b128 v2, v[148:151] offset:16
    ds_write_b128 v2, v[152:155] offset:128
    ds_write_b128 v2, v[156:159] offset:144
    s_mov_b64 exec, -1
    s_waitcnt lgkmcnt(0)
L2_slow_round:
    s_barrier
    v_mov_b32 v208, 0x7f00
    v_mov_b32 v209, 0x7f00
    v_mov_b32 v210, 0x7f00
    v_mov_b32 v211, 0x7f00
    v_lshlrev_b32 v212, 4, v0
    ds_write_b128 v212, v[208:211] offset:6144
    ds_write_b128 v212, v[208:211] offset:14336
    ds_write_b128 v212, v[208:211] offset:22528
    v_cmp_gt_u32 vcc, 83, v0
    v_lshlrev_b32 v213, 2, v0
    s_mov_b32 s40, 260
    v_mov_b32 v214, 5884
    s_mov_b64 exec, vcc
    ds_write_b128 v212, v[208:211] offset:30720
    s_mov_b64 exec, -1
    v_mad_u32_u24 v214, v0, s40, v214
    s_cmp_lt_u32 s16, 168
    s_addc_u32 s40, 97, 0
    v_cmp_lt_u32 vcc, s40, v0
    v_subrev_u32 v215, 4, v214
    v_mov_b32 v212, 136
    v_cndmask_b32 v214, v214, v215, vcc
    v_cmp_gt_u32 vcc, v212, v0
    v_mov_b32 v212, 220
    v_mov_b32 v215, 0
    v_cndmask_b32 v214, v215, v214, vcc
    v_cmp_gt_u32 vcc, v212, v0
    s_mov_b64 exec, vcc
    ds_write_b32 v213, v214
    s_mov_b64 exec, -1
    s_waitcnt lgkmcnt(0)
    s_barrier
L2_slow_step:
    s_cmp_lt_u32 s38, 800000
    s_cbranch_scc1 L2_slow_go
    s_mov_b32 s30, 2
    s_branch L2_build
L2_slow_go:
    v_add_u32 v2, s38, v0
    v_cmp_gt_u32 vcc, 800000, v2
    v_min_u32 v2, 799999, v2
    v_lshlrev_b32 v3, 1, v2
    v_lshlrev_b32 v2, 2, v2
    global_load_dword v208, v2, s[70:71]
    global_load_dword v209, v2, s[68:69]
    global_load_ushort v210, v3, s[66:67]
    v_cmp_eq_u32_e64 s[40:41], 0, v39
    s_and_b64 s[40:41], s[40:41], vcc
    s_mov_b32 s3, 260
    v_mov_b32 v212, 6392
    v_mov_b32 v2, 4
    s_waitcnt vmcnt(0)
    v_and_b32 v3, 255, v208
    v_cmp_eq_u32 vcc, s16, v3
    v_lshrrev_b32 v3, 8, v208
    v_mad_u32_u24 v212, v3, s3, v212
    v_lshlrev_b32 v3, 2, v3
    v_and_b32 v213, 255, v209
    v_lshrrev_b32 v209, 8, v209
    v_mul_u32_u24 v213, 98, v213
    v_add_u32 v209, v209, v213
    v_lshl_or_b32 v209, v210, 16, v209
    s_and_b64 exec, vcc, s[40:41]
    ds_add_rtn_u32 v211, v3, v2 offset:4
    s_waitcnt lgkmcnt(0)
    v_cmp_lt_u32 vcc, v211, v212
    s_andn2_b64 s[40:41], exec, vcc
    s_mov_b64 exec, vcc
    ds_write_b32 v211, v209
    v_mov_b32 v39, 1
    s_mov_b64 exec, s[40:41]
    v_mov_b32 v213, 588
    ds_write_b32 v213, v2
    s_mov_b64 exec, -1
    s_waitcnt lgkmcnt(0)
    s_barrier
    s_mov_b64 exec, s[40:41]
    ds_min_u32 v3, v212 offset:4
    s_mov_b64 exec, -1
    v_mov_b32 v213, 588
    ds_read_b32 v213, v213
    s_waitcnt lgkmcnt(0)
    v_cmp_ne_u32 vcc, 0, v213
    s_cbranch_vccnz L2_build
    s_barrier
    s_add_u32 s38, s38, 512
    v_mov_b32 v39, 0
    s_branch L2_slow_step
.section .rodata,"a"
.p2align 6
.amdhsa_kernel standalone__mpnn_edge_mlp__graph_kernel
  .amdhsa_next_free_vgpr 256
  .amdhsa_next_free_sgpr 96
  .amdhsa_accum_offset 256
  .amdhsa_group_segment_fixed_size 0
  .amdhsa_kernarg_size 72
  .amdhsa_user_sgpr_count 2
  .amdhsa_user_sgpr_kernarg_segment_ptr 1
  .amdhsa_system_sgpr_workgroup_id_x 1
  .amdhsa_float_denorm_mode_32 3
.end_amdhsa_kernel
```
